```python
import torch

def _softmax(x, axis=-1):
    return torch.softmax(x, dim=axis)

def _gelu(x):
    return torch.nn.functional.gelu(x, approximate='tanh')

def _silu(x):
    return torch.nn.functional.silu(x)

def _sigmoid(x):
    return torch.sigmoid(x)

def _layernorm(x, axis=-1, eps=1e-05):
    m = x.mean(dim=axis, keepdim=True)
    v = x.var(dim=axis, keepdim=True, unbiased=False)
    return (x - m) / torch.sqrt(v + eps)

def _scatter_add(tgt, idx, src, axis=0):
    return tgt.clone().index_add_(axis, idx, src)

def _segment_sum(src, seg, n):
    out = torch.zeros((n,) + src.shape[1:], dtype=src.dtype)
    return out.index_add_(0, seg, src)

def _pad(x, pw):
    flat = tuple((v for pair in reversed(pw) for v in pair))
    return torch.nn.functional.pad(x, flat)
kernel_name = 'adaLN_cond__compressed_kv_cla__dense_activation_relu__prompt'

def setup_inputs():

    _w = lambda a: (lambda t: t.to(torch.bfloat16) if t.is_floating_point() else t)(torch.as_tensor(a))

    def _A_setup():
        B, H, Sq, Sk, D, M = (1, 32, 2048, 2048, 128, 512)
        Dc = 4 * D
        return {'x': _w((lambda *s: torch.randn(*s, dtype=torch.bfloat16) * 0.05)(B, Sq, M)), 'c_kv': _w((lambda *s: torch.randn(*s, dtype=torch.bfloat16) * 1.6)(B, Sk, Dc)), 'w_q': _w((lambda *s: torch.randn(*s, dtype=torch.bfloat16) * 0.8)(M, H, D) * M ** (-0.5)), 'w_uk': _w((lambda *s: torch.randn(*s, dtype=torch.bfloat16) * 0.8)(Dc, H, D) * Dc ** (-0.5)), 'w_uv': _w((lambda *s: torch.randn(*s, dtype=torch.bfloat16) * 1.6)(Dc, H, D) * Dc ** (-0.5)), 'w_o': _w((lambda *s: torch.randn(*s, dtype=torch.bfloat16) * 1.6)(H, D, M) * (H * D) ** (-0.5))}
    _A_in = _A_setup()

    def _B_setup():
        B, S, D, Dff = (1, 2048, 512, 1792)
        return {'x': _w((lambda *s: torch.randn(*s, dtype=torch.bfloat16) * 0.05)(B, S, D)), 'w1': _w((lambda *s: torch.randn(*s, dtype=torch.bfloat16) * 0.05)(D, Dff)), 'w2': _w((lambda *s: torch.randn(*s, dtype=torch.bfloat16) * 0.05)(Dff, D))}
    _B_in = _B_setup()
    return {'A_x': _A_in['x'], 'A_c_kv': _A_in['c_kv'], 'A_w_q': _A_in['w_q'], 'A_w_uk': _A_in['w_uk'], 'A_w_uv': _A_in['w_uv'], 'A_w_o': _A_in['w_o'], 'B_x': _B_in['x'], 'B_w1': _B_in['w1'], 'B_w2': _B_in['w2'], 'c': _w((lambda *s: torch.randn(*s, dtype=torch.bfloat16) * 0.1)(1, 512) * 8.0), 'w_mod': _w((lambda *s: torch.randn(*s, dtype=torch.bfloat16) * 0.1)(512, 6 * 512) * 512 ** (-0.5) * 8.0)}

def reference(A_x, A_c_kv, A_w_q, A_w_uk, A_w_uv, A_w_o, B_x, B_w1, B_w2, c, w_mod):

    def _A_ref(x, c_kv, w_q, w_uk, w_uv, w_o):
        B, Sq, M = (x.shape[0], x.shape[1], x.shape[2])
        Sk = c_kv.shape[1]
        H, D = (w_q.shape[1], w_q.shape[2])
        q = torch.einsum('bqm,mhd->bhqd', x, w_q)
        k = torch.einsum('bkc,chd->bhkd', c_kv, w_uk)
        v = torch.einsum('bkc,chd->bhkd', c_kv, w_uv)
        scores = torch.einsum('bhqd,bhkd->bhqk', q, k) * D ** (-0.5)
        off = Sk - Sq
        qi = torch.arange(Sq)[:, None]
        kj = torch.arange(Sk)[None, :]
        cmask = kj <= qi + off
        scores = torch.where(cmask[None, None], scores, -1000000000.0)
        p = _softmax(scores, axis=-1)
        ctx = torch.einsum('bhqk,bhkd->bhqd', p, v)
        return torch.einsum('bhqd,hdm->bqm', ctx, w_o)

    def _B_ref(x, w1, w2):
        h = torch.einsum('bsd,df->bsf', x, w1)
        zero = torch.zeros_like(h)
        h = torch.maximum(h, zero)
        return torch.einsum('bsf,fd->bsd', h, w2)
    x = A_x
    mod = (_silu(c) @ w_mod).reshape(c.shape[0], 6, 1, -1)
    sa, ca, ga, sb, cb, gb = (mod[:, 0].clone(), mod[:, 1].clone(), mod[:, 2].clone(), mod[:, 3].clone(), mod[:, 4].clone(), mod[:, 5].clone())
    h = _layernorm(x, axis=-1) * (1 + ca) + sa
    x = x + ga * _A_ref(h, A_c_kv, A_w_q, A_w_uk, A_w_uv, A_w_o)
    h = _layernorm(x, axis=-1) * (1 + cb) + sb
    x = x + gb * _B_ref(h, B_w1, B_w2)
    return x
```

```asm
; @launch kernel=mod_kernel grid=(448,1,1) block=(256,1,1) lds=9216
; @launch kernel=ln1_kernel grid=(512,1,1) block=(256,1,1) lds=0
; @launch kernel=qkv_kernel grid=(1656,1,1) block=(256,1,1) lds=65536
; @launch kernel=attn_kernel grid=(256,1,1) block=(512,1,1) lds=131072
; @launch kernel=oproj_kernel grid=(256,1,1) block=(256,1,1) lds=67584
; @launch kernel=ln2_kernel grid=(512,1,1) block=(256,1,1) lds=0
; @launch kernel=ffn1_kernel grid=(224,1,1) block=(256,1,1) lds=65536
; @launch kernel=ffn2_kernel grid=(256,1,1) block=(256,1,1) lds=43008
.amdgcn_target "amdgcn-amd-amdhsa--gfx950"
.text
.globl mod_kernel
.p2align 8
.type mod_kernel,@function
mod_kernel:
    s_cmp_ge_u32 s2, 192
    s_cbranch_scc1 .Lmod_kernel_pf
    s_load_dwordx2 s[4:5], s[0:1], 72
    s_load_dwordx2 s[6:7], s[0:1], 80
    s_load_dwordx2 s[8:9], s[0:1], 104
    s_waitcnt lgkmcnt(0)
    s_mov_b32 s12, s4
    s_and_b32 s13, s5, 0xffff
    s_mov_b32 s14, 0x400
    s_mov_b32 s15, 0x20000
    s_mov_b32 s16, s6
    s_and_b32 s17, s7, 0xffff
    s_mov_b32 s18, 0x300000
    s_mov_b32 s19, 0x20000
    s_mov_b32 s20, s8
    s_and_b32 s21, s9, 0xffff
    s_mov_b32 s22, 0x3000
    s_mov_b32 s23, 0x20000
    v_and_b32 v1, 1, v0
    v_lshrrev_b32 v2, 1, v0
    v_lshlrev_b32 v3, 3, v2
    buffer_load_dwordx2 v[8:9], v3, s[12:15], 0 offen
    s_lshl_b32 s24, s2, 5
    v_mul_u32_u24 v4, 4*6144, v2
    v_lshlrev_b32 v5, 4, v1
    v_add_u32 v4, v4, v5
    v_add_u32 v4, s24, v4
    buffer_load_dwordx4 v[64:67], v4, s[16:19], 0 offen
    v_add_u32 v4, 6144, v4
    buffer_load_dwordx4 v[68:71], v4, s[16:19], 0 offen
    v_add_u32 v4, 6144, v4
    buffer_load_dwordx4 v[72:75], v4, s[16:19], 0 offen
    v_add_u32 v4, 6144, v4
    buffer_load_dwordx4 v[76:79], v4, s[16:19], 0 offen
    s_waitcnt vmcnt(4)
    v_lshlrev_b32 v16, 16, v8
    v_and_b32 v17, 0xffff0000, v8
    v_lshlrev_b32 v18, 16, v9
    v_and_b32 v19, 0xffff0000, v9
    v_mul_f32 v32, 0xbfb8aa3b, v16
    v_exp_f32 v32, v32
    s_nop 0
    v_add_f32 v32, 1.0, v32
    v_rcp_f32 v32, v32
    s_nop 0
    v_mul_f32 v16, v16, v32
    v_cvt_pk_bf16_f32 v16, v16, v16
    v_lshlrev_b32 v16, 16, v16
    v_mul_f32 v32, 0xbfb8aa3b, v17
    v_exp_f32 v32, v32
    s_nop 0
    v_add_f32 v32, 1.0, v32
    v_rcp_f32 v32, v32
    s_nop 0
    v_mul_f32 v17, v17, v32
    v_cvt_pk_bf16_f32 v17, v17, v17
    v_lshlrev_b32 v17, 16, v17
    v_mul_f32 v32, 0xbfb8aa3b, v18
    v_exp_f32 v32, v32
    s_nop 0
    v_add_f32 v32, 1.0, v32
    v_rcp_f32 v32, v32
    s_nop 0
    v_mul_f32 v18, v18, v32
    v_cvt_pk_bf16_f32 v18, v18, v18
    v_lshlrev_b32 v18, 16, v18
    v_mul_f32 v32, 0xbfb8aa3b, v19
    v_exp_f32 v32, v32
    s_nop 0
    v_add_f32 v32, 1.0, v32
    v_rcp_f32 v32, v32
    s_nop 0
    v_mul_f32 v19, v19, v32
    v_cvt_pk_bf16_f32 v19, v19, v19
    v_lshlrev_b32 v19, 16, v19
    v_mov_b32 v40, 0
    v_mov_b32 v41, 0
    v_mov_b32 v42, 0
    v_mov_b32 v43, 0
    v_mov_b32 v44, 0
    v_mov_b32 v45, 0
    v_mov_b32 v46, 0
    v_mov_b32 v47, 0
    s_waitcnt vmcnt(0)
    v_lshlrev_b32 v32, 16, v64
    v_and_b32 v33, 0xffff0000, v64
    v_fmac_f32 v40, v32, v16
    v_fmac_f32 v41, v33, v16
    v_lshlrev_b32 v32, 16, v65
    v_and_b32 v33, 0xffff0000, v65
    v_fmac_f32 v42, v32, v16
    v_fmac_f32 v43, v33, v16
    v_lshlrev_b32 v32, 16, v66
    v_and_b32 v33, 0xffff0000, v66
    v_fmac_f32 v44, v32, v16
    v_fmac_f32 v45, v33, v16
    v_lshlrev_b32 v32, 16, v67
    v_and_b32 v33, 0xffff0000, v67
    v_fmac_f32 v46, v32, v16
    v_fmac_f32 v47, v33, v16
    v_lshlrev_b32 v32, 16, v68
    v_and_b32 v33, 0xffff0000, v68
    v_fmac_f32 v40, v32, v17
    v_fmac_f32 v41, v33, v17
    v_lshlrev_b32 v32, 16, v69
    v_and_b32 v33, 0xffff0000, v69
    v_fmac_f32 v42, v32, v17
    v_fmac_f32 v43, v33, v17
    v_lshlrev_b32 v32, 16, v70
    v_and_b32 v33, 0xffff0000, v70
    v_fmac_f32 v44, v32, v17
    v_fmac_f32 v45, v33, v17
    v_lshlrev_b32 v32, 16, v71
    v_and_b32 v33, 0xffff0000, v71
    v_fmac_f32 v46, v32, v17
    v_fmac_f32 v47, v33, v17
    v_lshlrev_b32 v32, 16, v72
    v_and_b32 v33, 0xffff0000, v72
    v_fmac_f32 v40, v32, v18
    v_fmac_f32 v41, v33, v18
    v_lshlrev_b32 v32, 16, v73
    v_and_b32 v33, 0xffff0000, v73
    v_fmac_f32 v42, v32, v18
    v_fmac_f32 v43, v33, v18
    v_lshlrev_b32 v32, 16, v74
    v_and_b32 v33, 0xffff0000, v74
    v_fmac_f32 v44, v32, v18
    v_fmac_f32 v45, v33, v18
    v_lshlrev_b32 v32, 16, v75
    v_and_b32 v33, 0xffff0000, v75
    v_fmac_f32 v46, v32, v18
    v_fmac_f32 v47, v33, v18
    v_lshlrev_b32 v32, 16, v76
    v_and_b32 v33, 0xffff0000, v76
    v_fmac_f32 v40, v32, v19
    v_fmac_f32 v41, v33, v19
    v_lshlrev_b32 v32, 16, v77
    v_and_b32 v33, 0xffff0000, v77
    v_fmac_f32 v42, v32, v19
    v_fmac_f32 v43, v33, v19
    v_lshlrev_b32 v32, 16, v78
    v_and_b32 v33, 0xffff0000, v78
    v_fmac_f32 v44, v32, v19
    v_fmac_f32 v45, v33, v19
    v_lshlrev_b32 v32, 16, v79
    v_and_b32 v33, 0xffff0000, v79
    v_fmac_f32 v46, v32, v19
    v_fmac_f32 v47, v33, v19
    v_lshlrev_b32 v5, 6, v2
    v_lshlrev_b32 v6, 5, v1
    v_add_u32 v5, v5, v6
    ds_write_b128 v5, v[40:43]
    ds_write_b128 v5, v[44:47] offset:16
    s_waitcnt lgkmcnt(0)
    s_barrier
    v_and_b32 v5, 15, v0
    v_lshrrev_b32 v6, 4, v0
    v_lshlrev_b32 v7, 9, v6
    v_lshlrev_b32 v9, 2, v5
    v_add_u32 v7, v7, v9
    ds_read_b32 v64, v7 offset:0
    ds_read_b32 v65, v7 offset:64
    ds_read_b32 v66, v7 offset:128
    ds_read_b32 v67, v7 offset:192
    ds_read_b32 v68, v7 offset:256
    ds_read_b32 v69, v7 offset:320
    ds_read_b32 v70, v7 offset:384
    ds_read_b32 v71, v7 offset:448
    s_waitcnt lgkmcnt(0)
    v_add_f32 v64, v64, v65
    v_add_f32 v64, v64, v66
    v_add_f32 v64, v64, v67
    v_add_f32 v64, v64, v68
    v_add_f32 v64, v64, v69
    v_add_f32 v64, v64, v70
    v_add_f32 v64, v64, v71
    v_lshlrev_b32 v7, 6, v6
    v_add_u32 v7, v7, v9
    ds_write_b32 v7, v64 offset:8192
    s_waitcnt lgkmcnt(0)
    s_barrier
    v_cmp_gt_u32 vcc, 16, v0
    s_nop 0
    s_and_saveexec_b64 s[26:27], vcc
    s_nop 2
    s_cbranch_execz .Lmod_kernel_end
    ds_read_b32 v64, v9 offset:8192
    ds_read_b32 v65, v9 offset:8256
    ds_read_b32 v66, v9 offset:8320
    ds_read_b32 v67, v9 offset:8384
    ds_read_b32 v68, v9 offset:8448
    ds_read_b32 v69, v9 offset:8512
    ds_read_b32 v70, v9 offset:8576
    ds_read_b32 v71, v9 offset:8640
    ds_read_b32 v72, v9 offset:8704
    ds_read_b32 v73, v9 offset:8768
    ds_read_b32 v74, v9 offset:8832
    ds_read_b32 v75, v9 offset:8896
    ds_read_b32 v76, v9 offset:8960
    ds_read_b32 v77, v9 offset:9024
    ds_read_b32 v78, v9 offset:9088
    ds_read_b32 v79, v9 offset:9152
    s_waitcnt lgkmcnt(0)
    v_add_f32 v64, v64, v65
    v_add_f32 v64, v64, v66
    v_add_f32 v64, v64, v67
    v_add_f32 v64, v64, v68
    v_add_f32 v64, v64, v69
    v_add_f32 v64, v64, v70
    v_add_f32 v64, v64, v71
    v_add_f32 v64, v64, v72
    v_add_f32 v64, v64, v73
    v_add_f32 v64, v64, v74
    v_add_f32 v64, v64, v75
    v_add_f32 v64, v64, v76
    v_add_f32 v64, v64, v77
    v_add_f32 v64, v64, v78
    v_add_f32 v64, v64, v79
    v_cvt_pk_bf16_f32 v64, v64, v64
    v_lshlrev_b32 v64, 16, v64
    s_lshl_b32 s24, s2, 6
    v_add_u32 v9, s24, v9
    buffer_store_dword v64, v9, s[20:23], 0 offen
    s_nop 3
    s_branch .Lmod_kernel_end
.Lmod_kernel_pf:
    s_sub_u32 s3, s2, 192
    s_cmp_ge_u32 s3, 256
    s_cbranch_scc1 .Lmod_kernel_end
    s_cmp_ge_u32 s3, 32
    s_cbranch_scc1 .Lmod_kernel_pf0
    s_load_dwordx2 s[4:5], s[0:1], 8
    s_sub_u32 s3, s3, 0
    s_waitcnt lgkmcnt(0)
    s_mov_b32 s12, s4
    s_and_b32 s13, s5, 0xffff
    s_mov_b32 s14, 0x200000
    s_mov_b32 s15, 0x20000
    s_branch .Lmod_kernel_pfgo
.Lmod_kernel_pf0:
    s_cmp_ge_u32 s3, 96
    s_cbranch_scc1 .Lmod_kernel_pf1
    s_load_dwordx2 s[4:5], s[0:1], 16
    s_sub_u32 s3, s3, 32
    s_waitcnt lgkmcnt(0)
    s_mov_b32 s12, s4
    s_and_b32 s13, s5, 0xffff
    s_mov_b32 s14, 0x400000
    s_mov_b32 s15, 0x20000
    s_branch .Lmod_kernel_pfgo
.Lmod_kernel_pf1:
    s_cmp_ge_u32 s3, 160
    s_cbranch_scc1 .Lmod_kernel_pf2
    s_load_dwordx2 s[4:5], s[0:1], 24
    s_sub_u32 s3, s3, 96
    s_waitcnt lgkmcnt(0)
    s_mov_b32 s12, s4
    s_and_b32 s13, s5, 0xffff
    s_mov_b32 s14, 0x400000
    s_mov_b32 s15, 0x20000
    s_branch .Lmod_kernel_pfgo
.Lmod_kernel_pf2:
    s_cmp_ge_u32 s3, 224
    s_cbranch_scc1 .Lmod_kernel_pf3
    s_load_dwordx2 s[4:5], s[0:1], 32
    s_sub_u32 s3, s3, 160
    s_waitcnt lgkmcnt(0)
    s_mov_b32 s12, s4
    s_and_b32 s13, s5, 0xffff
    s_mov_b32 s14, 0x400000
    s_mov_b32 s15, 0x20000
    s_branch .Lmod_kernel_pfgo
.Lmod_kernel_pf3:
    s_cmp_ge_u32 s3, 256
    s_cbranch_scc1 .Lmod_kernel_pf4
    s_load_dwordx2 s[4:5], s[0:1], 0
    s_sub_u32 s3, s3, 224
    s_waitcnt lgkmcnt(0)
    s_mov_b32 s12, s4
    s_and_b32 s13, s5, 0xffff
    s_mov_b32 s14, 0x200000
    s_mov_b32 s15, 0x20000
    s_branch .Lmod_kernel_pfgo
.Lmod_kernel_pf4:
.Lmod_kernel_pfgo:
    s_lshl_b32 s3, s3, 16
    v_lshlrev_b32 v1, 4, v0
    s_add_u32 s16, s3, 0
    buffer_load_dwordx4 v[16:19], v1, s[12:15], s16 offen
    s_add_u32 s16, s3, 4096
    buffer_load_dwordx4 v[20:23], v1, s[12:15], s16 offen
    s_add_u32 s16, s3, 8192
    buffer_load_dwordx4 v[24:27], v1, s[12:15], s16 offen
    s_add_u32 s16, s3, 12288
    buffer_load_dwordx4 v[28:31], v1, s[12:15], s16 offen
    s_add_u32 s16, s3, 16384
    buffer_load_dwordx4 v[32:35], v1, s[12:15], s16 offen
    s_add_u32 s16, s3, 20480
    buffer_load_dwordx4 v[36:39], v1, s[12:15], s16 offen
    s_add_u32 s16, s3, 24576
    buffer_load_dwordx4 v[40:43], v1, s[12:15], s16 offen
    s_add_u32 s16, s3, 28672
    buffer_load_dwordx4 v[44:47], v1, s[12:15], s16 offen
    s_add_u32 s16, s3, 32768
    buffer_load_dwordx4 v[48:51], v1, s[12:15], s16 offen
    s_add_u32 s16, s3, 36864
    buffer_load_dwordx4 v[52:55], v1, s[12:15], s16 offen
    s_add_u32 s16, s3, 40960
    buffer_load_dwordx4 v[56:59], v1, s[12:15], s16 offen
    s_add_u32 s16, s3, 45056
    buffer_load_dwordx4 v[60:63], v1, s[12:15], s16 offen
    s_add_u32 s16, s3, 49152
    buffer_load_dwordx4 v[64:67], v1, s[12:15], s16 offen
    s_add_u32 s16, s3, 53248
    buffer_load_dwordx4 v[68:71], v1, s[12:15], s16 offen
    s_add_u32 s16, s3, 57344
    buffer_load_dwordx4 v[72:75], v1, s[12:15], s16 offen
    s_add_u32 s16, s3, 61440
    buffer_load_dwordx4 v[76:79], v1, s[12:15], s16 offen
    s_waitcnt vmcnt(0)
.Lmod_kernel_end:
    s_endpgm
.globl ln1_kernel
.p2align 8
.type ln1_kernel,@function
ln1_kernel:
    s_cmp_ge_u32 s2, 512
    s_cbranch_scc1 .Lln1_kernel_end
    s_load_dwordx2 s[4:5], s[0:1], 0
    s_load_dwordx2 s[8:9], s[0:1], 104
    s_waitcnt lgkmcnt(0)
    s_mov_b32 s12, s4
    s_and_b32 s13, s5, 0xffff
    s_mov_b32 s14, 0x200000
    s_mov_b32 s15, 0x20000
    s_mov_b32 s16, s8
    s_and_b32 s17, s9, 0xffff
    s_mov_b32 s18, 0x3000
    s_mov_b32 s19, 0x20000
    s_add_u32 s20, s8, 0x100000
    s_addc_u32 s21, s9, 0x0
    s_and_b32 s21, s21, 0xffff
    s_mov_b32 s22, 0x200000
    s_mov_b32 s23, 0x20000
    v_and_b32 v1, 63, v0
    v_lshrrev_b32 v2, 6, v0
    s_lshl_b32 s24, s2, 2
    v_add_u32 v2, s24, v2
    v_lshlrev_b32 v3, 10, v2
    v_lshlrev_b32 v4, 4, v1
    v_add_u32 v3, v3, v4
    buffer_load_dwordx4 v[8:11], v3, s[12:15], 0 offen
    v_lshlrev_b32 v5, 5, v1
    v_add_u32 v6, 2048, v5
    buffer_load_dwordx4 v[40:43], v6, s[16:19], 0 offen
    buffer_load_dwordx4 v[44:47], v6, s[16:19], 0 offen offset:16
    v_add_u32 v6, 0, v5
    buffer_load_dwordx4 v[48:51], v6, s[16:19], 0 offen
    buffer_load_dwordx4 v[52:55], v6, s[16:19], 0 offen offset:16
    s_waitcnt vmcnt(4)
    v_lshlrev_b32 v16, 16, v8
    v_and_b32 v17, 0xffff0000, v8
    v_lshlrev_b32 v18, 16, v9
    v_and_b32 v19, 0xffff0000, v9
    v_lshlrev_b32 v20, 16, v10
    v_and_b32 v21, 0xffff0000, v10
    v_lshlrev_b32 v22, 16, v11
    v_and_b32 v23, 0xffff0000, v11
    v_add_f32 v24, v16, v17
    v_add_f32 v24, v24, v18
    v_add_f32 v24, v24, v19
    v_add_f32 v24, v24, v20
    v_add_f32 v24, v24, v21
    v_add_f32 v24, v24, v22
    v_add_f32 v24, v24, v23
    ds_swizzle_b32 v25, v24 offset:0x41f
    s_waitcnt lgkmcnt(0)
    v_add_f32 v24, v24, v25
    ds_swizzle_b32 v25, v24 offset:0x81f
    s_waitcnt lgkmcnt(0)
    v_add_f32 v24, v24, v25
    ds_swizzle_b32 v25, v24 offset:0x101f
    s_waitcnt lgkmcnt(0)
    v_add_f32 v24, v24, v25
    ds_swizzle_b32 v25, v24 offset:0x201f
    s_waitcnt lgkmcnt(0)
    v_add_f32 v24, v24, v25
    ds_swizzle_b32 v25, v24 offset:0x401f
    s_waitcnt lgkmcnt(0)
    v_add_f32 v24, v24, v25
    v_mov_b32 v25, v24
    s_nop 1
    v_permlane32_swap_b32 v24, v25
    v_add_f32 v24, v24, v25
    v_mul_f32 v24, 0x3b000000, v24
    v_mov_b32 v26, 0
    v_sub_f32 v27, v16, v24
    v_fmac_f32 v26, v27, v27
    v_sub_f32 v27, v17, v24
    v_fmac_f32 v26, v27, v27
    v_sub_f32 v27, v18, v24
    v_fmac_f32 v26, v27, v27
    v_sub_f32 v27, v19, v24
    v_fmac_f32 v26, v27, v27
    v_sub_f32 v27, v20, v24
    v_fmac_f32 v26, v27, v27
    v_sub_f32 v27, v21, v24
    v_fmac_f32 v26, v27, v27
    v_sub_f32 v27, v22, v24
    v_fmac_f32 v26, v27, v27
    v_sub_f32 v27, v23, v24
    v_fmac_f32 v26, v27, v27
    ds_swizzle_b32 v25, v26 offset:0x41f
    s_waitcnt lgkmcnt(0)
    v_add_f32 v26, v26, v25
    ds_swizzle_b32 v25, v26 offset:0x81f
    s_waitcnt lgkmcnt(0)
    v_add_f32 v26, v26, v25
    ds_swizzle_b32 v25, v26 offset:0x101f
    s_waitcnt lgkmcnt(0)
    v_add_f32 v26, v26, v25
    ds_swizzle_b32 v25, v26 offset:0x201f
    s_waitcnt lgkmcnt(0)
    v_add_f32 v26, v26, v25
    ds_swizzle_b32 v25, v26 offset:0x401f
    s_waitcnt lgkmcnt(0)
    v_add_f32 v26, v26, v25
    v_mov_b32 v25, v26
    s_nop 1
    v_permlane32_swap_b32 v26, v25
    v_add_f32 v26, v26, v25
    v_mul_f32 v26, 0x3b000000, v26
    v_cvt_pk_bf16_f32 v24, v24, v24
    v_lshlrev_b32 v24, 16, v24
    v_cvt_pk_bf16_f32 v26, v26, v26
    v_lshlrev_b32 v26, 16, v26
    v_add_f32 v26, 0x3727c5ac, v26
    v_cvt_pk_bf16_f32 v26, v26, v26
    v_lshlrev_b32 v26, 16, v26
    v_sqrt_f32 v26, v26
    s_nop 0
    v_cvt_pk_bf16_f32 v26, v26, v26
    v_lshlrev_b32 v26, 16, v26
    v_rcp_f32 v26, v26
    s_waitcnt vmcnt(0)
    v_sub_f32 v16, v16, v24
    v_cvt_pk_bf16_f32 v16, v16, v16
    v_lshlrev_b32 v16, 16, v16
    v_mul_f32 v16, v16, v26
    v_cvt_pk_bf16_f32 v16, v16, v16
    v_lshlrev_b32 v16, 16, v16
    v_add_f32 v40, 1.0, v40
    v_cvt_pk_bf16_f32 v40, v40, v40
    v_lshlrev_b32 v40, 16, v40
    v_mul_f32 v16, v16, v40
    v_cvt_pk_bf16_f32 v16, v16, v16
    v_lshlrev_b32 v16, 16, v16
    v_add_f32 v16, v16, v48
    v_sub_f32 v17, v17, v24
    v_cvt_pk_bf16_f32 v17, v17, v17
    v_lshlrev_b32 v17, 16, v17
    v_mul_f32 v17, v17, v26
    v_cvt_pk_bf16_f32 v17, v17, v17
    v_lshlrev_b32 v17, 16, v17
    v_add_f32 v41, 1.0, v41
    v_cvt_pk_bf16_f32 v41, v41, v41
    v_lshlrev_b32 v41, 16, v41
    v_mul_f32 v17, v17, v41
    v_cvt_pk_bf16_f32 v17, v17, v17
    v_lshlrev_b32 v17, 16, v17
    v_add_f32 v17, v17, v49
    v_sub_f32 v18, v18, v24
    v_cvt_pk_bf16_f32 v18, v18, v18
    v_lshlrev_b32 v18, 16, v18
    v_mul_f32 v18, v18, v26
    v_cvt_pk_bf16_f32 v18, v18, v18
    v_lshlrev_b32 v18, 16, v18
    v_add_f32 v42, 1.0, v42
    v_cvt_pk_bf16_f32 v42, v42, v42
    v_lshlrev_b32 v42, 16, v42
    v_mul_f32 v18, v18, v42
    v_cvt_pk_bf16_f32 v18, v18, v18
    v_lshlrev_b32 v18, 16, v18
    v_add_f32 v18, v18, v50
    v_sub_f32 v19, v19, v24
    v_cvt_pk_bf16_f32 v19, v19, v19
    v_lshlrev_b32 v19, 16, v19
    v_mul_f32 v19, v19, v26
    v_cvt_pk_bf16_f32 v19, v19, v19
    v_lshlrev_b32 v19, 16, v19
    v_add_f32 v43, 1.0, v43
    v_cvt_pk_bf16_f32 v43, v43, v43
    v_lshlrev_b32 v43, 16, v43
    v_mul_f32 v19, v19, v43
    v_cvt_pk_bf16_f32 v19, v19, v19
    v_lshlrev_b32 v19, 16, v19
    v_add_f32 v19, v19, v51
    v_sub_f32 v20, v20, v24
    v_cvt_pk_bf16_f32 v20, v20, v20
    v_lshlrev_b32 v20, 16, v20
    v_mul_f32 v20, v20, v26
    v_cvt_pk_bf16_f32 v20, v20, v20
    v_lshlrev_b32 v20, 16, v20
    v_add_f32 v44, 1.0, v44
    v_cvt_pk_bf16_f32 v44, v44, v44
    v_lshlrev_b32 v44, 16, v44
    v_mul_f32 v20, v20, v44
    v_cvt_pk_bf16_f32 v20, v20, v20
    v_lshlrev_b32 v20, 16, v20
    v_add_f32 v20, v20, v52
    v_sub_f32 v21, v21, v24
    v_cvt_pk_bf16_f32 v21, v21, v21
    v_lshlrev_b32 v21, 16, v21
    v_mul_f32 v21, v21, v26
    v_cvt_pk_bf16_f32 v21, v21, v21
    v_lshlrev_b32 v21, 16, v21
    v_add_f32 v45, 1.0, v45
    v_cvt_pk_bf16_f32 v45, v45, v45
    v_lshlrev_b32 v45, 16, v45
    v_mul_f32 v21, v21, v45
    v_cvt_pk_bf16_f32 v21, v21, v21
    v_lshlrev_b32 v21, 16, v21
    v_add_f32 v21, v21, v53
    v_sub_f32 v22, v22, v24
    v_cvt_pk_bf16_f32 v22, v22, v22
    v_lshlrev_b32 v22, 16, v22
    v_mul_f32 v22, v22, v26
    v_cvt_pk_bf16_f32 v22, v22, v22
    v_lshlrev_b32 v22, 16, v22
    v_add_f32 v46, 1.0, v46
    v_cvt_pk_bf16_f32 v46, v46, v46
    v_lshlrev_b32 v46, 16, v46
    v_mul_f32 v22, v22, v46
    v_cvt_pk_bf16_f32 v22, v22, v22
    v_lshlrev_b32 v22, 16, v22
    v_add_f32 v22, v22, v54
    v_sub_f32 v23, v23, v24
    v_cvt_pk_bf16_f32 v23, v23, v23
    v_lshlrev_b32 v23, 16, v23
    v_mul_f32 v23, v23, v26
    v_cvt_pk_bf16_f32 v23, v23, v23
    v_lshlrev_b32 v23, 16, v23
    v_add_f32 v47, 1.0, v47
    v_cvt_pk_bf16_f32 v47, v47, v47
    v_lshlrev_b32 v47, 16, v47
    v_mul_f32 v23, v23, v47
    v_cvt_pk_bf16_f32 v23, v23, v23
    v_lshlrev_b32 v23, 16, v23
    v_add_f32 v23, v23, v55
    v_cvt_pk_bf16_f32 v8, v16, v17
    v_cvt_pk_bf16_f32 v9, v18, v19
    v_cvt_pk_bf16_f32 v10, v20, v21
    v_cvt_pk_bf16_f32 v11, v22, v23
    buffer_store_dwordx4 v[8:11], v3, s[20:23], 0 offen
    s_nop 3
.Lln1_kernel_end:
    s_endpgm
.globl qkv_kernel
.p2align 8
.type qkv_kernel,@function
qkv_kernel:
    s_cmp_ge_u32 s2, 1536
    s_cbranch_scc1 .Lqkv_kernel_pf
    s_load_dwordx2 s[4:5], s[0:1], 8
    s_load_dwordx4 s[40:43], s[0:1], 16
    s_load_dwordx2 s[44:45], s[0:1], 32
    s_load_dwordx2 s[8:9], s[0:1], 104
    s_waitcnt lgkmcnt(0)
    s_and_b32 s49, s2, 7
    s_lshr_b32 s50, s2, 3
    s_mul_hi_u32 s46, s50, 0x15555556
    s_mul_i32 s51, s46, 12
    s_sub_u32 s51, s50, s51
    s_mul_i32 s47, s49, 12
    s_add_u32 s47, s47, s51
    s_lshr_b32 s48, s47, 5
    s_and_b32 s47, s47, 31
    s_cmp_eq_u32 s48, 0
    s_cbranch_scc0 .Lqkv_kernel_kv
    s_add_u32 s12, s8, 0x100000
    s_addc_u32 s13, s9, 0x0
    s_and_b32 s13, s13, 0xffff
    s_mov_b32 s14, 0x200000
    s_mov_b32 s15, 0x20000
    s_mov_b32 s16, s40
    s_and_b32 s17, s41, 0xffff
    s_mov_b32 s18, 0x400000
    s_mov_b32 s19, 0x20000
    s_add_u32 s20, s8, 0x400000
    s_addc_u32 s21, s9, 0x0
    s_and_b32 s21, s21, 0xffff
    s_mov_b32 s22, 0x1000000
    s_mov_b32 s23, 0x20000
    s_branch .Lqkv_kernel_go
.Lqkv_kernel_kv:
    s_mov_b32 s12, s4
    s_and_b32 s13, s5, 0xffff
    s_mov_b32 s14, 0x200000
    s_mov_b32 s15, 0x20000
    s_cmp_eq_u32 s48, 1
    s_cbranch_scc0 .Lqkv_kernel_v
    s_mov_b32 s16, s42
    s_and_b32 s17, s43, 0xffff
    s_mov_b32 s18, 0x400000
    s_mov_b32 s19, 0x20000
    s_add_u32 s20, s8, 0x1400000
    s_addc_u32 s21, s9, 0x0
    s_and_b32 s21, s21, 0xffff
    s_mov_b32 s22, 0x1000000
    s_mov_b32 s23, 0x20000
    s_branch .Lqkv_kernel_go
.Lqkv_kernel_v:
    s_mov_b32 s16, s44
    s_and_b32 s17, s45, 0xffff
    s_mov_b32 s18, 0x400000
    s_mov_b32 s19, 0x20000
    s_add_u32 s20, s8, 0x2400000
    s_addc_u32 s21, s9, 0x0
    s_and_b32 s21, s21, 0xffff
    s_mov_b32 s22, 0x1000000
    s_mov_b32 s23, 0x20000
.Lqkv_kernel_go:
    s_mul_i32 s24, s46, 131072
    s_lshl_b32 s25, s47, 8
    s_lshl_b32 s26, s47, 19
    s_lshl_b32 s27, s46, 15
    s_add_u32 s26, s26, s27
    s_mov_b32 s28, 0
    s_mov_b32 s29, 0
    v_and_b32 v1, 63, v0
    v_lshrrev_b32 v2, 6, v0
    s_nop 0
    v_readfirstlane_b32 s52, v2
    s_nop 0
    s_lshl_b32 s53, s52, 10
    v_lshrrev_b32 v3, 3, v1
    v_lshlrev_b32 v4, 3, v2
    v_add_u32 v3, v3, v4
    v_lshrrev_b32 v4, 1, v3
    v_and_b32 v4, 7, v4
    v_and_b32 v5, 7, v1
    v_xor_b32 v4, v4, v5
    v_mul_u32_u24 v5, 1024, v3
    v_lshlrev_b32 v4, 4, v4
    v_add_u32 v5, v5, v4
    v_add_u32 v5, s24, v5
    v_lshrrev_b32 v3, 4, v1
    v_lshrrev_b32 v4, 2, v1
    v_and_b32 v4, 3, v4
    v_xor_b32 v4, v4, v3
    v_lshlrev_b32 v4, 2, v4
    v_and_b32 v6, 3, v1
    v_add_u32 v4, v4, v6
    v_lshlrev_b32 v6, 2, v2
    v_add_u32 v3, v3, v6
    v_mul_u32_u24 v8, 8192, v3
    v_lshlrev_b32 v4, 4, v4
    v_add_u32 v8, v8, v4
    v_add_u32 v8, s25, v8
    v_lshrrev_b32 v3, 1, v2
    v_and_b32 v4, 1, v2
    v_and_b32 v6, 31, v1
    v_lshrrev_b32 v7, 5, v1
    v_lshlrev_b32 v9, 6, v3
    v_add_u32 v9, v9, v6
    v_lshlrev_b32 v9, 7, v9
    v_lshrrev_b32 v14, 1, v6
    v_and_b32 v14, 7, v14
    v_add_u32 v15, 0, v7
    v_xor_b32 v15, v15, v14
    v_lshlrev_b32 v15, 4, v15
    v_add_u32 v10, v9, v15
    v_add_u32 v15, 2, v7
    v_xor_b32 v15, v15, v14
    v_lshlrev_b32 v15, 4, v15
    v_add_u32 v11, v9, v15
    v_add_u32 v15, 4, v7
    v_xor_b32 v15, v15, v14
    v_lshlrev_b32 v15, 4, v15
    v_add_u32 v12, v9, v15
    v_add_u32 v15, 6, v7
    v_xor_b32 v15, v15, v14
    v_lshlrev_b32 v15, 4, v15
    v_add_u32 v13, v9, v15
    v_and_b32 v9, 15, v1
    v_lshrrev_b32 v14, 2, v9
    v_lshlrev_b32 v15, 3, v7
    v_add_u32 v15, v15, v14
    v_lshlrev_b32 v15, 8, v15
    v_and_b32 v9, 3, v9
    v_lshlrev_b32 v9, 3, v9
    v_add_u32 v15, v15, v9
    v_lshrrev_b32 v9, 4, v1
    v_and_b32 v9, 1, v9
    v_lshlrev_b32 v9, 5, v9
    v_add_u32 v15, v15, v9
    v_add_u32 v15, 16384, v15
    v_lshlrev_b32 v9, 1, v4
    v_xor_b32 v7, v9, v14
    v_lshlrev_b32 v7, 6, v7
    v_add_u32 v7, v15, v7
    v_add_u32 v9, 1, v9
    v_xor_b32 v9, v9, v14
    v_lshlrev_b32 v9, 6, v9
    v_add_u32 v15, v15, v9
    s_add_u32 m0, s53, 0
    s_add_u32 s31, s28, 0
    buffer_load_dwordx4 v5, s[12:15], s31 offen lds
    s_add_u32 m0, s53, 4096
    s_add_u32 s31, s28, 32768
    buffer_load_dwordx4 v5, s[12:15], s31 offen lds
    s_add_u32 m0, s53, 8192
    s_add_u32 s31, s28, 65536
    buffer_load_dwordx4 v5, s[12:15], s31 offen lds
    s_add_u32 m0, s53, 12288
    s_add_u32 s31, s28, 98304
    buffer_load_dwordx4 v5, s[12:15], s31 offen lds
    s_add_u32 m0, s53, 16384
    s_add_u32 s31, s29, 0
    buffer_load_dwordx4 v8, s[16:19], s31 offen lds
    s_add_u32 m0, s53, 20480
    s_add_u32 s31, s29, 131072
    buffer_load_dwordx4 v8, s[16:19], s31 offen lds
    s_add_u32 m0, s53, 24576
    s_add_u32 s31, s29, 262144
    buffer_load_dwordx4 v8, s[16:19], s31 offen lds
    s_add_u32 m0, s53, 28672
    s_add_u32 s31, s29, 393216
    buffer_load_dwordx4 v8, s[16:19], s31 offen lds
    s_add_u32 s28, s28, 128
    s_add_u32 s29, s29, 524288
    v_mov_b32 v16, 0
    v_mov_b32 v17, 0
    v_mov_b32 v18, 0
    v_mov_b32 v19, 0
    v_mov_b32 v20, 0
    v_mov_b32 v21, 0
    v_mov_b32 v22, 0
    v_mov_b32 v23, 0
    v_mov_b32 v24, 0
    v_mov_b32 v25, 0
    v_mov_b32 v26, 0
    v_mov_b32 v27, 0
    v_mov_b32 v28, 0
    v_mov_b32 v29, 0
    v_mov_b32 v30, 0
    v_mov_b32 v31, 0
    v_mov_b32 v32, 0
    v_mov_b32 v33, 0
    v_mov_b32 v34, 0
    v_mov_b32 v35, 0
    v_mov_b32 v36, 0
    v_mov_b32 v37, 0
    v_mov_b32 v38, 0
    v_mov_b32 v39, 0
    v_mov_b32 v40, 0
    v_mov_b32 v41, 0
    v_mov_b32 v42, 0
    v_mov_b32 v43, 0
    v_mov_b32 v44, 0
    v_mov_b32 v45, 0
    v_mov_b32 v46, 0
    v_mov_b32 v47, 0
    v_mov_b32 v48, 0
    v_mov_b32 v49, 0
    v_mov_b32 v50, 0
    v_mov_b32 v51, 0
    v_mov_b32 v52, 0
    v_mov_b32 v53, 0
    v_mov_b32 v54, 0
    v_mov_b32 v55, 0
    v_mov_b32 v56, 0
    v_mov_b32 v57, 0
    v_mov_b32 v58, 0
    v_mov_b32 v59, 0
    v_mov_b32 v60, 0
    v_mov_b32 v61, 0
    v_mov_b32 v62, 0
    v_mov_b32 v63, 0
    v_mov_b32 v64, 0
    v_mov_b32 v65, 0
    v_mov_b32 v66, 0
    v_mov_b32 v67, 0
    v_mov_b32 v68, 0
    v_mov_b32 v69, 0
    v_mov_b32 v70, 0
    v_mov_b32 v71, 0
    v_mov_b32 v72, 0
    v_mov_b32 v73, 0
    v_mov_b32 v74, 0
    v_mov_b32 v75, 0
    v_mov_b32 v76, 0
    v_mov_b32 v77, 0
    v_mov_b32 v78, 0
    v_mov_b32 v79, 0
    s_mov_b32 s30, 4
    s_nop 3
.Lqkv_kernel_loop:
    s_waitcnt vmcnt(0)
    s_barrier
    ds_read_b128 v[80:83], v10 offset:0
    ds_read_b128 v[84:87], v10 offset:4096
    ds_read_b64_tr_b16 v[96:97], v7 offset:0
    ds_read_b64_tr_b16 v[98:99], v7 offset:1024
    ds_read_b64_tr_b16 v[100:101], v15 offset:0
    ds_read_b64_tr_b16 v[102:103], v15 offset:1024
    ds_read_b128 v[88:91], v11 offset:0
    ds_read_b128 v[92:95], v11 offset:4096
    ds_read_b64_tr_b16 v[104:105], v7 offset:4096
    ds_read_b64_tr_b16 v[106:107], v7 offset:5120
    ds_read_b64_tr_b16 v[108:109], v15 offset:4096
    ds_read_b64_tr_b16 v[110:111], v15 offset:5120
    s_waitcnt lgkmcnt(6)
    v_mfma_f32_32x32x16_bf16 v[16:31], v[96:99], v[80:83], v[16:31]
    s_add_u32 m0, s53, 32768
    s_add_u32 s31, s28, 0
    buffer_load_dwordx4 v5, s[12:15], s31 offen lds
    v_mfma_f32_32x32x16_bf16 v[32:47], v[100:103], v[80:83], v[32:47]
    s_add_u32 m0, s53, 36864
    s_add_u32 s31, s28, 32768
    buffer_load_dwordx4 v5, s[12:15], s31 offen lds
    v_mfma_f32_32x32x16_bf16 v[48:63], v[96:99], v[84:87], v[48:63]
    s_add_u32 m0, s53, 40960
    s_add_u32 s31, s28, 65536
    buffer_load_dwordx4 v5, s[12:15], s31 offen lds
    v_mfma_f32_32x32x16_bf16 v[64:79], v[100:103], v[84:87], v[64:79]
    s_add_u32 m0, s53, 45056
    s_add_u32 s31, s28, 98304
    buffer_load_dwordx4 v5, s[12:15], s31 offen lds
    ds_read_b128 v[80:83], v12 offset:0
    ds_read_b128 v[84:87], v12 offset:4096
    ds_read_b64_tr_b16 v[96:97], v7 offset:8192
    ds_read_b64_tr_b16 v[98:99], v7 offset:9216
    ds_read_b64_tr_b16 v[100:101], v15 offset:8192
    ds_read_b64_tr_b16 v[102:103], v15 offset:9216
    s_waitcnt lgkmcnt(6)
    v_mfma_f32_32x32x16_bf16 v[16:31], v[104:107], v[88:91], v[16:31]
    s_add_u32 m0, s53, 49152
    s_add_u32 s31, s29, 0
    buffer_load_dwordx4 v8, s[16:19], s31 offen lds
    v_mfma_f32_32x32x16_bf16 v[32:47], v[108:111], v[88:91], v[32:47]
    s_add_u32 m0, s53, 53248
    s_add_u32 s31, s29, 131072
    buffer_load_dwordx4 v8, s[16:19], s31 offen lds
    v_mfma_f32_32x32x16_bf16 v[48:63], v[104:107], v[92:95], v[48:63]
    s_add_u32 m0, s53, 57344
    s_add_u32 s31, s29, 262144
    buffer_load_dwordx4 v8, s[16:19], s31 offen lds
    v_mfma_f32_32x32x16_bf16 v[64:79], v[108:111], v[92:95], v[64:79]
    s_add_u32 m0, s53, 61440
    s_add_u32 s31, s29, 393216
    buffer_load_dwordx4 v8, s[16:19], s31 offen lds
    s_add_u32 s28, s28, 128
    s_add_u32 s29, s29, 524288
    ds_read_b128 v[88:91], v13 offset:0
    ds_read_b128 v[92:95], v13 offset:4096
    ds_read_b64_tr_b16 v[104:105], v7 offset:12288
    ds_read_b64_tr_b16 v[106:107], v7 offset:13312
    ds_read_b64_tr_b16 v[108:109], v15 offset:12288
    ds_read_b64_tr_b16 v[110:111], v15 offset:13312
    s_waitcnt lgkmcnt(6)
    v_mfma_f32_32x32x16_bf16 v[16:31], v[96:99], v[80:83], v[16:31]
    v_mfma_f32_32x32x16_bf16 v[32:47], v[100:103], v[80:83], v[32:47]
    v_mfma_f32_32x32x16_bf16 v[48:63], v[96:99], v[84:87], v[48:63]
    v_mfma_f32_32x32x16_bf16 v[64:79], v[100:103], v[84:87], v[64:79]
    s_waitcnt lgkmcnt(0)
    v_mfma_f32_32x32x16_bf16 v[16:31], v[104:107], v[88:91], v[16:31]
    v_mfma_f32_32x32x16_bf16 v[32:47], v[108:111], v[88:91], v[32:47]
    v_mfma_f32_32x32x16_bf16 v[48:63], v[104:107], v[92:95], v[48:63]
    v_mfma_f32_32x32x16_bf16 v[64:79], v[108:111], v[92:95], v[64:79]
    s_waitcnt vmcnt(0)
    s_barrier
    ds_read_b128 v[80:83], v10 offset:32768
    ds_read_b128 v[84:87], v10 offset:36864
    ds_read_b64_tr_b16 v[96:97], v7 offset:32768
    ds_read_b64_tr_b16 v[98:99], v7 offset:33792
    ds_read_b64_tr_b16 v[100:101], v15 offset:32768
    ds_read_b64_tr_b16 v[102:103], v15 offset:33792
    ds_read_b128 v[88:91], v11 offset:32768
    ds_read_b128 v[92:95], v11 offset:36864
    ds_read_b64_tr_b16 v[104:105], v7 offset:36864
    ds_read_b64_tr_b16 v[106:107], v7 offset:37888
    ds_read_b64_tr_b16 v[108:109], v15 offset:36864
    ds_read_b64_tr_b16 v[110:111], v15 offset:37888
    s_waitcnt lgkmcnt(6)
    v_mfma_f32_32x32x16_bf16 v[16:31], v[96:99], v[80:83], v[16:31]
    s_add_u32 m0, s53, 0
    s_add_u32 s31, s28, 0
    buffer_load_dwordx4 v5, s[12:15], s31 offen lds
    v_mfma_f32_32x32x16_bf16 v[32:47], v[100:103], v[80:83], v[32:47]
    s_add_u32 m0, s53, 4096
    s_add_u32 s31, s28, 32768
    buffer_load_dwordx4 v5, s[12:15], s31 offen lds
    v_mfma_f32_32x32x16_bf16 v[48:63], v[96:99], v[84:87], v[48:63]
    s_add_u32 m0, s53, 8192
    s_add_u32 s31, s28, 65536
    buffer_load_dwordx4 v5, s[12:15], s31 offen lds
    v_mfma_f32_32x32x16_bf16 v[64:79], v[100:103], v[84:87], v[64:79]
    s_add_u32 m0, s53, 12288
    s_add_u32 s31, s28, 98304
    buffer_load_dwordx4 v5, s[12:15], s31 offen lds
    ds_read_b128 v[80:83], v12 offset:32768
    ds_read_b128 v[84:87], v12 offset:36864
    ds_read_b64_tr_b16 v[96:97], v7 offset:40960
    ds_read_b64_tr_b16 v[98:99], v7 offset:41984
    ds_read_b64_tr_b16 v[100:101], v15 offset:40960
    ds_read_b64_tr_b16 v[102:103], v15 offset:41984
    s_waitcnt lgkmcnt(6)
    v_mfma_f32_32x32x16_bf16 v[16:31], v[104:107], v[88:91], v[16:31]
    s_add_u32 m0, s53, 16384
    s_add_u32 s31, s29, 0
    buffer_load_dwordx4 v8, s[16:19], s31 offen lds
    v_mfma_f32_32x32x16_bf16 v[32:47], v[108:111], v[88:91], v[32:47]
    s_add_u32 m0, s53, 20480
    s_add_u32 s31, s29, 131072
    buffer_load_dwordx4 v8, s[16:19], s31 offen lds
    v_mfma_f32_32x32x16_bf16 v[48:63], v[104:107], v[92:95], v[48:63]
    s_add_u32 m0, s53, 24576
    s_add_u32 s31, s29, 262144
    buffer_load_dwordx4 v8, s[16:19], s31 offen lds
    v_mfma_f32_32x32x16_bf16 v[64:79], v[108:111], v[92:95], v[64:79]
    s_add_u32 m0, s53, 28672
    s_add_u32 s31, s29, 393216
    buffer_load_dwordx4 v8, s[16:19], s31 offen lds
    s_add_u32 s28, s28, 128
    s_add_u32 s29, s29, 524288
    ds_read_b128 v[88:91], v13 offset:32768
    ds_read_b128 v[92:95], v13 offset:36864
    ds_read_b64_tr_b16 v[104:105], v7 offset:45056
    ds_read_b64_tr_b16 v[106:107], v7 offset:46080
    ds_read_b64_tr_b16 v[108:109], v15 offset:45056
    ds_read_b64_tr_b16 v[110:111], v15 offset:46080
    s_waitcnt lgkmcnt(6)
    v_mfma_f32_32x32x16_bf16 v[16:31], v[96:99], v[80:83], v[16:31]
    v_mfma_f32_32x32x16_bf16 v[32:47], v[100:103], v[80:83], v[32:47]
    v_mfma_f32_32x32x16_bf16 v[48:63], v[96:99], v[84:87], v[48:63]
    v_mfma_f32_32x32x16_bf16 v[64:79], v[100:103], v[84:87], v[64:79]
    s_waitcnt lgkmcnt(0)
    v_mfma_f32_32x32x16_bf16 v[16:31], v[104:107], v[88:91], v[16:31]
    v_mfma_f32_32x32x16_bf16 v[32:47], v[108:111], v[88:91], v[32:47]
    v_mfma_f32_32x32x16_bf16 v[48:63], v[104:107], v[92:95], v[48:63]
    v_mfma_f32_32x32x16_bf16 v[64:79], v[108:111], v[92:95], v[64:79]
    s_sub_u32 s30, s30, 1
    s_cmp_lg_u32 s30, 0
    s_nop 9
    s_cbranch_scc1 .Lqkv_kernel_loop
    s_waitcnt vmcnt(0)
    v_lshlrev_b32 v5, 6, v3
    v_add_u32 v5, v5, v6
    v_lshlrev_b32 v7, 6, v4
    v_lshrrev_b32 v8, 5, v1
    v_lshlrev_b32 v8, 2, v8
    v_add_u32 v7, v7, v8
    s_barrier
    v_mul_u32_u24 v9, 272, v5
    v_lshlrev_b32 v10, 1, v7
    v_add_u32 v9, v9, v10
    v_cvt_pk_bf16_f32 v16, v16, v17
    v_cvt_pk_bf16_f32 v17, v18, v19
    ds_write_b64 v9, v[16:17] offset:0
    v_cvt_pk_bf16_f32 v20, v20, v21
    v_cvt_pk_bf16_f32 v21, v22, v23
    ds_write_b64 v9, v[20:21] offset:16
    v_cvt_pk_bf16_f32 v24, v24, v25
    v_cvt_pk_bf16_f32 v25, v26, v27
    ds_write_b64 v9, v[24:25] offset:32
    v_cvt_pk_bf16_f32 v28, v28, v29
    v_cvt_pk_bf16_f32 v29, v30, v31
    ds_write_b64 v9, v[28:29] offset:48
    v_cvt_pk_bf16_f32 v32, v32, v33
    v_cvt_pk_bf16_f32 v33, v34, v35
    ds_write_b64 v9, v[32:33] offset:64
    v_cvt_pk_bf16_f32 v36, v36, v37
    v_cvt_pk_bf16_f32 v37, v38, v39
    ds_write_b64 v9, v[36:37] offset:80
    v_cvt_pk_bf16_f32 v40, v40, v41
    v_cvt_pk_bf16_f32 v41, v42, v43
    ds_write_b64 v9, v[40:41] offset:96
    v_cvt_pk_bf16_f32 v44, v44, v45
    v_cvt_pk_bf16_f32 v45, v46, v47
    ds_write_b64 v9, v[44:45] offset:112
    v_cvt_pk_bf16_f32 v48, v48, v49
    v_cvt_pk_bf16_f32 v49, v50, v51
    ds_write_b64 v9, v[48:49] offset:8704
    v_cvt_pk_bf16_f32 v52, v52, v53
    v_cvt_pk_bf16_f32 v53, v54, v55
    ds_write_b64 v9, v[52:53] offset:8720
    v_cvt_pk_bf16_f32 v56, v56, v57
    v_cvt_pk_bf16_f32 v57, v58, v59
    ds_write_b64 v9, v[56:57] offset:8736
    v_cvt_pk_bf16_f32 v60, v60, v61
    v_cvt_pk_bf16_f32 v61, v62, v63
    ds_write_b64 v9, v[60:61] offset:8752
    v_cvt_pk_bf16_f32 v64, v64, v65
    v_cvt_pk_bf16_f32 v65, v66, v67
    ds_write_b64 v9, v[64:65] offset:8768
    v_cvt_pk_bf16_f32 v68, v68, v69
    v_cvt_pk_bf16_f32 v69, v70, v71
    ds_write_b64 v9, v[68:69] offset:8784
    v_cvt_pk_bf16_f32 v72, v72, v73
    v_cvt_pk_bf16_f32 v73, v74, v75
    ds_write_b64 v9, v[72:73] offset:8800
    v_cvt_pk_bf16_f32 v76, v76, v77
    v_cvt_pk_bf16_f32 v77, v78, v79
    ds_write_b64 v9, v[76:77] offset:8816
    v_lshrrev_b32 v3, 4, v0
    v_and_b32 v4, 15, v0
    v_lshlrev_b32 v4, 4, v4
    v_mul_u32_u24 v9, 272, v3
    v_add_u32 v9, v9, v4
    v_mul_u32_u24 v10, 256, v3
    v_add_u32 v10, v10, v4
    v_add_u32 v10, s26, v10
    s_waitcnt lgkmcnt(0)
    s_barrier
    ds_read_b128 v[16:19], v9 offset:0
    ds_read_b128 v[20:23], v9 offset:4352
    ds_read_b128 v[24:27], v9 offset:8704
    ds_read_b128 v[28:31], v9 offset:13056
    ds_read_b128 v[32:35], v9 offset:17408
    ds_read_b128 v[36:39], v9 offset:21760
    ds_read_b128 v[40:43], v9 offset:26112
    ds_read_b128 v[44:47], v9 offset:30464
    s_waitcnt lgkmcnt(7)
    s_mov_b32 s31, 0
    buffer_store_dwordx4 v[16:19], v10, s[20:23], s31 offen
    s_waitcnt lgkmcnt(6)
    s_mov_b32 s31, 4096
    buffer_store_dwordx4 v[20:23], v10, s[20:23], s31 offen
    s_waitcnt lgkmcnt(5)
    s_mov_b32 s31, 8192
    buffer_store_dwordx4 v[24:27], v10, s[20:23], s31 offen
    s_waitcnt lgkmcnt(4)
    s_mov_b32 s31, 12288
    buffer_store_dwordx4 v[28:31], v10, s[20:23], s31 offen
    s_waitcnt lgkmcnt(3)
    s_mov_b32 s31, 16384
    buffer_store_dwordx4 v[32:35], v10, s[20:23], s31 offen
    s_waitcnt lgkmcnt(2)
    s_mov_b32 s31, 20480
    buffer_store_dwordx4 v[36:39], v10, s[20:23], s31 offen
    s_waitcnt lgkmcnt(1)
    s_mov_b32 s31, 24576
    buffer_store_dwordx4 v[40:43], v10, s[20:23], s31 offen
    s_waitcnt lgkmcnt(0)
    s_mov_b32 s31, 28672
    buffer_store_dwordx4 v[44:47], v10, s[20:23], s31 offen
    s_nop 1
    s_branch .Lqkv_kernel_end
.Lqkv_kernel_pf:
    s_sub_u32 s3, s2, 1536
    s_cmp_ge_u32 s3, 120
    s_cbranch_scc1 .Lqkv_kernel_end
    s_cmp_ge_u32 s3, 64
    s_cbranch_scc1 .Lqkv_kernel_pf0
    s_load_dwordx2 s[4:5], s[0:1], 40
    s_sub_u32 s3, s3, 0
    s_waitcnt lgkmcnt(0)
    s_mov_b32 s12, s4
    s_and_b32 s13, s5, 0xffff
    s_mov_b32 s14, 0x400000
    s_mov_b32 s15, 0x20000
    s_branch .Lqkv_kernel_pfgo
.Lqkv_kernel_pf0:
    s_cmp_ge_u32 s3, 92
    s_cbranch_scc1 .Lqkv_kernel_pf1
    s_load_dwordx2 s[4:5], s[0:1], 56
    s_sub_u32 s3, s3, 64
    s_waitcnt lgkmcnt(0)
    s_mov_b32 s12, s4
    s_and_b32 s13, s5, 0xffff
    s_mov_b32 s14, 0x1c0000
    s_mov_b32 s15, 0x20000
    s_branch .Lqkv_kernel_pfgo
.Lqkv_kernel_pf1:
    s_cmp_ge_u32 s3, 120
    s_cbranch_scc1 .Lqkv_kernel_pf2
    s_load_dwordx2 s[4:5], s[0:1], 64
    s_sub_u32 s3, s3, 92
    s_waitcnt lgkmcnt(0)
    s_mov_b32 s12, s4
    s_and_b32 s13, s5, 0xffff
    s_mov_b32 s14, 0x1c0000
    s_mov_b32 s15, 0x20000
    s_branch .Lqkv_kernel_pfgo
.Lqkv_kernel_pf2:
.Lqkv_kernel_pfgo:
    s_lshl_b32 s3, s3, 16
    v_lshlrev_b32 v1, 4, v0
    s_add_u32 s16, s3, 0
    buffer_load_dwordx4 v[16:19], v1, s[12:15], s16 offen
    s_add_u32 s16, s3, 4096
    buffer_load_dwordx4 v[20:23], v1, s[12:15], s16 offen
    s_add_u32 s16, s3, 8192
    buffer_load_dwordx4 v[24:27], v1, s[12:15], s16 offen
    s_add_u32 s16, s3, 12288
    buffer_load_dwordx4 v[28:31], v1, s[12:15], s16 offen
    s_add_u32 s16, s3, 16384
    buffer_load_dwordx4 v[32:35], v1, s[12:15], s16 offen
    s_add_u32 s16, s3, 20480
    buffer_load_dwordx4 v[36:39], v1, s[12:15], s16 offen
    s_add_u32 s16, s3, 24576
    buffer_load_dwordx4 v[40:43], v1, s[12:15], s16 offen
    s_add_u32 s16, s3, 28672
    buffer_load_dwordx4 v[44:47], v1, s[12:15], s16 offen
    s_add_u32 s16, s3, 32768
    buffer_load_dwordx4 v[48:51], v1, s[12:15], s16 offen
    s_add_u32 s16, s3, 36864
    buffer_load_dwordx4 v[52:55], v1, s[12:15], s16 offen
    s_add_u32 s16, s3, 40960
    buffer_load_dwordx4 v[56:59], v1, s[12:15], s16 offen
    s_add_u32 s16, s3, 45056
    buffer_load_dwordx4 v[60:63], v1, s[12:15], s16 offen
    s_add_u32 s16, s3, 49152
    buffer_load_dwordx4 v[64:67], v1, s[12:15], s16 offen
    s_add_u32 s16, s3, 53248
    buffer_load_dwordx4 v[68:71], v1, s[12:15], s16 offen
    s_add_u32 s16, s3, 57344
    buffer_load_dwordx4 v[72:75], v1, s[12:15], s16 offen
    s_add_u32 s16, s3, 61440
    buffer_load_dwordx4 v[76:79], v1, s[12:15], s16 offen
    s_waitcnt vmcnt(0)
.Lqkv_kernel_end:
    s_endpgm
.globl attn_kernel
.p2align 8
.type attn_kernel,@function
attn_kernel:
    s_cmp_ge_u32 s2, 256
    s_cbranch_scc1 .Lattn_kernel_end
    s_load_dwordx2 s[8:9], s[0:1], 104
    s_waitcnt lgkmcnt(0)
    s_add_u32 s12, s8, 0x400000
    s_addc_u32 s13, s9, 0x0
    s_and_b32 s13, s13, 0xffff
    s_mov_b32 s14, 0x1000000
    s_mov_b32 s15, 0x20000
    s_add_u32 s16, s8, 0x1400000
    s_addc_u32 s17, s9, 0x0
    s_and_b32 s17, s17, 0xffff
    s_mov_b32 s18, 0x1000000
    s_mov_b32 s19, 0x20000
    s_add_u32 s20, s8, 0x2400000
    s_addc_u32 s21, s9, 0x0
    s_and_b32 s21, s21, 0xffff
    s_mov_b32 s22, 0x1000000
    s_mov_b32 s23, 0x20000
    s_add_u32 s24, s8, 0x3400000
    s_addc_u32 s25, s9, 0x0
    s_and_b32 s25, s25, 0xffff
    s_mov_b32 s26, 0x1000000
    s_mov_b32 s27, 0x20000
    s_and_b32 s28, s2, 31
    s_lshr_b32 s44, s2, 5
    s_sub_u32 s29, 15, s44
    s_mov_b32 s45, 0
    s_lshl_b32 s32, s28, 8
    s_lshl_b32 s31, s28, 19
    v_and_b32 v1, 63, v0
    v_lshrrev_b32 v2, 6, v0
    s_nop 0
    v_readfirstlane_b32 s38, v2
    s_nop 0
    s_lshr_b32 s43, s38, 2
    s_and_b32 s38, s38, 3
    v_and_b32 v2, 3, v2
    v_and_b32 v3, 31, v1
    v_lshrrev_b32 v4, 5, v1
    v_lshrrev_b32 v7, 4, v1
    v_lshlrev_b32 v8, 2, v2
    v_add_u32 v8, v8, v7
    v_and_b32 v10, 15, v1
    v_and_b32 v11, 15, v8
    v_xor_b32 v11, v11, v10
    v_lshlrev_b32 v9, 8, v8
    v_add_u32 v9, s31, v9
    v_lshlrev_b32 v11, 4, v11
    v_add_u32 v11, v9, v11
    v_lshrrev_b32 v12, 2, v10
    v_xor_b32 v12, v12, v7
    v_lshlrev_b32 v12, 2, v12
    v_and_b32 v13, 3, v10
    v_add_u32 v12, v12, v13
    v_lshlrev_b32 v12, 4, v12
    v_add_u32 v12, v9, v12
    s_lshl_b32 s46, s43, 16
    v_and_b32 v13, 15, v3
    v_xor_b32 v13, v13, v4
    v_lshlrev_b32 v13, 4, v13
    v_lshlrev_b32 v14, 8, v3
    v_add_u32 v13, v13, v14
    v_add_u32 v13, s46, v13
    v_xor_b32 v192, 0, v13
    v_xor_b32 v193, 32, v13
    v_xor_b32 v194, 64, v13
    v_xor_b32 v195, 96, v13
    v_xor_b32 v196, 128, v13
    v_xor_b32 v197, 160, v13
    v_xor_b32 v198, 192, v13
    v_xor_b32 v199, 224, v13
    v_lshrrev_b32 v13, 2, v10
    v_lshlrev_b32 v14, 2, v4
    v_add_u32 v14, v14, v13
    v_lshlrev_b32 v14, 8, v14
    v_and_b32 v15, 1, v7
    v_lshlrev_b32 v15, 5, v15
    v_add_u32 v14, v14, v15
    v_and_b32 v15, 3, v10
    v_lshlrev_b32 v15, 3, v15
    v_add_u32 v14, v14, v15
    v_add_u32 v14, 16384, v14
    v_add_u32 v14, s46, v14
    v_xor_b32 v15, 0, v13
    v_lshlrev_b32 v15, 6, v15
    v_add_u32 v200, v14, v15
    v_xor_b32 v15, 1, v13
    v_lshlrev_b32 v15, 6, v15
    v_add_u32 v201, v14, v15
    v_xor_b32 v15, 2, v13
    v_lshlrev_b32 v15, 6, v15
    v_add_u32 v202, v14, v15
    v_xor_b32 v15, 3, v13
    v_lshlrev_b32 v15, 6, v15
    v_add_u32 v203, v14, v15
    s_lshl_b32 s41, s38, 10
    s_add_u32 s41, s41, s46
    s_mov_b32 s39, 0x3e0293ee
    s_mov_b32 s42, 0x427af232
    v_mul_u32_u24 v15, 9216, v2
    v_lshlrev_b32 v14, 4, v1
    v_add_u32 v216, v15, v14
    s_nop 4
.Lattn_kernel_qblock:
    s_lshl_b32 s33, s29, 7
    s_add_u32 s34, s29, 1
    s_mov_b32 s47, 0
    s_mov_b32 s35, s43
    s_mov_b32 s36, 0
    s_lshl_b32 s48, s38, 5
    s_add_u32 s48, s48, s33
    s_add_u32 s37, s48, 31
    s_lshr_b32 s37, s37, 6
    s_cmp_eq_u32 s43, 0
    s_cbranch_scc0 .Lattn_kernel_nov0
    s_add_u32 m0, s41, 0
    s_add_u32 s40, s36, 0
    buffer_load_dwordx4 v11, s[16:19], s40 offen lds
    s_add_u32 m0, s41, 65536
    s_add_u32 s40, s36, 16384
    buffer_load_dwordx4 v11, s[16:19], s40 offen lds
    s_add_u32 m0, s41, 4096
    s_add_u32 s40, s36, 4096
    buffer_load_dwordx4 v11, s[16:19], s40 offen lds
    s_add_u32 m0, s41, 69632
    s_add_u32 s40, s36, 20480
    buffer_load_dwordx4 v11, s[16:19], s40 offen lds
    s_add_u32 m0, s41, 8192
    s_add_u32 s40, s36, 8192
    buffer_load_dwordx4 v11, s[16:19], s40 offen lds
    s_add_u32 m0, s41, 73728
    s_add_u32 s40, s36, 24576
    buffer_load_dwordx4 v11, s[16:19], s40 offen lds
    s_add_u32 m0, s41, 12288
    s_add_u32 s40, s36, 12288
    buffer_load_dwordx4 v11, s[16:19], s40 offen lds
    s_add_u32 m0, s41, 77824
    s_add_u32 s40, s36, 28672
    buffer_load_dwordx4 v11, s[16:19], s40 offen lds
    s_add_u32 s36, s36, 32768
.Lattn_kernel_nov0:
    v_lshlrev_b32 v5, 5, v2
    v_add_u32 v5, v5, v3
    v_add_u32 v5, s33, v5
    v_lshlrev_b32 v6, 8, v5
    v_lshlrev_b32 v7, 4, v4
    v_add_u32 v6, v6, v7
    v_add_u32 v6, s31, v6
    buffer_load_dwordx4 v[16:19], v6, s[12:15], 0 offen offset:0
    buffer_load_dwordx4 v[20:23], v6, s[12:15], 0 offen offset:32
    buffer_load_dwordx4 v[24:27], v6, s[12:15], 0 offen offset:64
    buffer_load_dwordx4 v[28:31], v6, s[12:15], 0 offen offset:96
    buffer_load_dwordx4 v[32:35], v6, s[12:15], 0 offen offset:128
    buffer_load_dwordx4 v[36:39], v6, s[12:15], 0 offen offset:160
    buffer_load_dwordx4 v[40:43], v6, s[12:15], 0 offen offset:192
    buffer_load_dwordx4 v[44:47], v6, s[12:15], 0 offen offset:224
    v_mov_b32 v48, 0
    v_mov_b32 v49, 0
    v_mov_b32 v50, 0
    v_mov_b32 v51, 0
    v_mov_b32 v52, 0
    v_mov_b32 v53, 0
    v_mov_b32 v54, 0
    v_mov_b32 v55, 0
    v_mov_b32 v56, 0
    v_mov_b32 v57, 0
    v_mov_b32 v58, 0
    v_mov_b32 v59, 0
    v_mov_b32 v60, 0
    v_mov_b32 v61, 0
    v_mov_b32 v62, 0
    v_mov_b32 v63, 0
    v_mov_b32 v64, 0
    v_mov_b32 v65, 0
    v_mov_b32 v66, 0
    v_mov_b32 v67, 0
    v_mov_b32 v68, 0
    v_mov_b32 v69, 0
    v_mov_b32 v70, 0
    v_mov_b32 v71, 0
    v_mov_b32 v72, 0
    v_mov_b32 v73, 0
    v_mov_b32 v74, 0
    v_mov_b32 v75, 0
    v_mov_b32 v76, 0
    v_mov_b32 v77, 0
    v_mov_b32 v78, 0
    v_mov_b32 v79, 0
    v_mov_b32 v80, 0
    v_mov_b32 v81, 0
    v_mov_b32 v82, 0
    v_mov_b32 v83, 0
    v_mov_b32 v84, 0
    v_mov_b32 v85, 0
    v_mov_b32 v86, 0
    v_mov_b32 v87, 0
    v_mov_b32 v88, 0
    v_mov_b32 v89, 0
    v_mov_b32 v90, 0
    v_mov_b32 v91, 0
    v_mov_b32 v92, 0
    v_mov_b32 v93, 0
    v_mov_b32 v94, 0
    v_mov_b32 v95, 0
    v_mov_b32 v96, 0
    v_mov_b32 v97, 0
    v_mov_b32 v98, 0
    v_mov_b32 v99, 0
    v_mov_b32 v100, 0
    v_mov_b32 v101, 0
    v_mov_b32 v102, 0
    v_mov_b32 v103, 0
    v_mov_b32 v104, 0
    v_mov_b32 v105, 0
    v_mov_b32 v106, 0
    v_mov_b32 v107, 0
    v_mov_b32 v108, 0
    v_mov_b32 v109, 0
    v_mov_b32 v110, 0
    v_mov_b32 v111, 0
    v_mov_b32 v204, 0xff800000
    v_mov_b32 v211, 0xff800000
    v_mov_b32 v212, 0
    v_mov_b32 v213, 0
    v_mov_b32 v214, s39
    v_mov_b32 v215, s39
    v_mov_b32 v205, 0
    s_waitcnt vmcnt(0)
    s_cmp_eq_u32 s43, 0
    s_nop 2
    s_cbranch_scc0 .Lattn_kernel_g1pre
.Lattn_kernel_loop:
    s_waitcnt vmcnt(0)
    s_barrier
    s_cmp_gt_u32 s35, s37
    s_cbranch_scc1 .Lattn_kernel_skipd0
    ds_read_b128 v[160:163], v192 offset:0
    ds_read_b128 v[164:167], v193 offset:0
    ds_read_b128 v[168:171], v194 offset:0
    ds_read_b128 v[172:175], v195 offset:0
    ds_read_b128 v[176:179], v196 offset:0
    ds_read_b128 v[180:183], v197 offset:0
    ds_read_b128 v[184:187], v198 offset:0
    ds_read_b128 v[188:191], v199 offset:0
    s_waitcnt lgkmcnt(7)
    v_mfma_f32_32x32x16_bf16 v[112:127], v[160:163], v[16:19], 0
    s_add_u32 m0, s41, 32768
    s_add_u32 s40, s36, 0
    buffer_load_dwordx4 v11, s[16:19], s40 offen lds
    ds_read_b128 v[160:163], v192 offset:8192
    s_waitcnt lgkmcnt(7)
    v_mfma_f32_32x32x16_bf16 v[112:127], v[164:167], v[20:23], v[112:127]
    s_add_u32 m0, s41, 16384
    s_add_u32 s40, s36, -32768
    buffer_load_dwordx4 v12, s[20:23], s40 offen lds
    ds_read_b128 v[164:167], v193 offset:8192
    s_waitcnt lgkmcnt(7)
    v_mfma_f32_32x32x16_bf16 v[112:127], v[168:171], v[24:27], v[112:127]
    s_add_u32 m0, s41, 98304
    s_add_u32 s40, s36, 16384
    buffer_load_dwordx4 v11, s[16:19], s40 offen lds
    ds_read_b128 v[168:171], v194 offset:8192
    s_waitcnt lgkmcnt(7)
    v_mfma_f32_32x32x16_bf16 v[112:127], v[172:175], v[28:31], v[112:127]
    s_add_u32 m0, s41, 81920
    s_add_u32 s40, s36, -16384
    buffer_load_dwordx4 v12, s[20:23], s40 offen lds
    ds_read_b128 v[172:175], v195 offset:8192
    s_waitcnt lgkmcnt(7)
    v_mfma_f32_32x32x16_bf16 v[112:127], v[176:179], v[32:35], v[112:127]
    s_add_u32 m0, s41, 36864
    s_add_u32 s40, s36, 4096
    buffer_load_dwordx4 v11, s[16:19], s40 offen lds
    ds_read_b128 v[176:179], v196 offset:8192
    s_waitcnt lgkmcnt(7)
    v_mfma_f32_32x32x16_bf16 v[112:127], v[180:183], v[36:39], v[112:127]
    s_add_u32 m0, s41, 20480
    s_add_u32 s40, s36, -28672
    buffer_load_dwordx4 v12, s[20:23], s40 offen lds
    ds_read_b128 v[180:183], v197 offset:8192
    s_waitcnt lgkmcnt(7)
    v_mfma_f32_32x32x16_bf16 v[112:127], v[184:187], v[40:43], v[112:127]
    s_add_u32 m0, s41, 102400
    s_add_u32 s40, s36, 20480
    buffer_load_dwordx4 v11, s[16:19], s40 offen lds
    ds_read_b128 v[184:187], v198 offset:8192
    s_waitcnt lgkmcnt(7)
    v_mfma_f32_32x32x16_bf16 v[112:127], v[188:191], v[44:47], v[112:127]
    s_add_u32 m0, s41, 86016
    s_add_u32 s40, s36, -12288
    buffer_load_dwordx4 v12, s[20:23], s40 offen lds
    ds_read_b128 v[188:191], v199 offset:8192
    s_waitcnt lgkmcnt(7)
    v_mfma_f32_32x32x16_bf16 v[128:143], v[160:163], v[16:19], 0
    s_add_u32 m0, s41, 40960
    s_add_u32 s40, s36, 8192
    buffer_load_dwordx4 v11, s[16:19], s40 offen lds
    s_waitcnt lgkmcnt(6)
    v_mfma_f32_32x32x16_bf16 v[128:143], v[164:167], v[20:23], v[128:143]
    s_add_u32 m0, s41, 24576
    s_add_u32 s40, s36, -24576
    buffer_load_dwordx4 v12, s[20:23], s40 offen lds
    s_waitcnt lgkmcnt(5)
    v_mfma_f32_32x32x16_bf16 v[128:143], v[168:171], v[24:27], v[128:143]
    s_add_u32 m0, s41, 106496
    s_add_u32 s40, s36, 24576
    buffer_load_dwordx4 v11, s[16:19], s40 offen lds
    s_waitcnt lgkmcnt(4)
    v_mfma_f32_32x32x16_bf16 v[128:143], v[172:175], v[28:31], v[128:143]
    s_add_u32 m0, s41, 90112
    s_add_u32 s40, s36, -8192
    buffer_load_dwordx4 v12, s[20:23], s40 offen lds
    s_waitcnt lgkmcnt(3)
    v_mfma_f32_32x32x16_bf16 v[128:143], v[176:179], v[32:35], v[128:143]
    s_add_u32 m0, s41, 45056
    s_add_u32 s40, s36, 12288
    buffer_load_dwordx4 v11, s[16:19], s40 offen lds
    s_waitcnt lgkmcnt(2)
    v_mfma_f32_32x32x16_bf16 v[128:143], v[180:183], v[36:39], v[128:143]
    s_add_u32 m0, s41, 28672
    s_add_u32 s40, s36, -20480
    buffer_load_dwordx4 v12, s[20:23], s40 offen lds
    s_waitcnt lgkmcnt(1)
    v_mfma_f32_32x32x16_bf16 v[128:143], v[184:187], v[40:43], v[128:143]
    s_add_u32 m0, s41, 110592
    s_add_u32 s40, s36, 28672
    buffer_load_dwordx4 v11, s[16:19], s40 offen lds
    s_waitcnt lgkmcnt(0)
    v_mfma_f32_32x32x16_bf16 v[128:143], v[188:191], v[44:47], v[128:143]
    s_add_u32 m0, s41, 94208
    s_add_u32 s40, s36, -4096
    buffer_load_dwordx4 v12, s[20:23], s40 offen lds
    s_add_u32 s36, s36, 32768
    s_nop 7
    s_branch .Lattn_kernel_skipq0
.Lattn_kernel_skipd0:
    s_add_u32 m0, s41, 32768
    s_add_u32 s40, s36, 0
    buffer_load_dwordx4 v11, s[16:19], s40 offen lds
    s_add_u32 m0, s41, 16384
    s_add_u32 s40, s36, -32768
    buffer_load_dwordx4 v12, s[20:23], s40 offen lds
    s_add_u32 m0, s41, 98304
    s_add_u32 s40, s36, 16384
    buffer_load_dwordx4 v11, s[16:19], s40 offen lds
    s_add_u32 m0, s41, 81920
    s_add_u32 s40, s36, -16384
    buffer_load_dwordx4 v12, s[20:23], s40 offen lds
    s_add_u32 m0, s41, 36864
    s_add_u32 s40, s36, 4096
    buffer_load_dwordx4 v11, s[16:19], s40 offen lds
    s_add_u32 m0, s41, 20480
    s_add_u32 s40, s36, -28672
    buffer_load_dwordx4 v12, s[20:23], s40 offen lds
    s_add_u32 m0, s41, 102400
    s_add_u32 s40, s36, 20480
    buffer_load_dwordx4 v11, s[16:19], s40 offen lds
    s_add_u32 m0, s41, 86016
    s_add_u32 s40, s36, -12288
    buffer_load_dwordx4 v12, s[20:23], s40 offen lds
    s_add_u32 m0, s41, 40960
    s_add_u32 s40, s36, 8192
    buffer_load_dwordx4 v11, s[16:19], s40 offen lds
    s_add_u32 m0, s41, 24576
    s_add_u32 s40, s36, -24576
    buffer_load_dwordx4 v12, s[20:23], s40 offen lds
    s_add_u32 m0, s41, 106496
    s_add_u32 s40, s36, 24576
    buffer_load_dwordx4 v11, s[16:19], s40 offen lds
    s_add_u32 m0, s41, 90112
    s_add_u32 s40, s36, -8192
    buffer_load_dwordx4 v12, s[20:23], s40 offen lds
    s_add_u32 m0, s41, 45056
    s_add_u32 s40, s36, 12288
    buffer_load_dwordx4 v11, s[16:19], s40 offen lds
    s_add_u32 m0, s41, 28672
    s_add_u32 s40, s36, -20480
    buffer_load_dwordx4 v12, s[20:23], s40 offen lds
    s_add_u32 m0, s41, 110592
    s_add_u32 s40, s36, 28672
    buffer_load_dwordx4 v11, s[16:19], s40 offen lds
    s_add_u32 m0, s41, 94208
    s_add_u32 s40, s36, -4096
    buffer_load_dwordx4 v12, s[20:23], s40 offen lds
    s_add_u32 s36, s36, 32768
.Lattn_kernel_skipq0:
    s_sub_u32 s50, s35, 2
    s_cmp_eq_u32 s47, 0
    s_cbranch_scc1 .Lattn_kernel_skipp0
    s_cmp_gt_u32 s50, s37
    s_cbranch_scc1 .Lattn_kernel_skipp0
    ds_read_b64_tr_b16 v[160:161], v200 offset:32768
    ds_read_b64_tr_b16 v[162:163], v200 offset:34816
    ds_read_b64_tr_b16 v[164:165], v201 offset:32768
    ds_read_b64_tr_b16 v[166:167], v201 offset:34816
    ds_read_b64_tr_b16 v[168:169], v202 offset:32768
    ds_read_b64_tr_b16 v[170:171], v202 offset:34816
    ds_read_b64_tr_b16 v[172:173], v203 offset:32768
    ds_read_b64_tr_b16 v[174:175], v203 offset:34816
    ds_read_b64_tr_b16 v[176:177], v200 offset:36864
    ds_read_b64_tr_b16 v[178:179], v200 offset:38912
    ds_read_b64_tr_b16 v[180:181], v201 offset:36864
    ds_read_b64_tr_b16 v[182:183], v201 offset:38912
    ds_read_b64_tr_b16 v[184:185], v202 offset:36864
    ds_read_b64_tr_b16 v[186:187], v202 offset:38912
    ds_read_b64_tr_b16 v[188:189], v203 offset:36864
    ds_read_b64_tr_b16 v[190:191], v203 offset:38912
    s_waitcnt lgkmcnt(14)
    v_mfma_f32_32x32x16_bf16 v[48:63], v[160:163], v[144:147], v[48:63]
    ds_read_b64_tr_b16 v[160:161], v200 offset:40960
    ds_read_b64_tr_b16 v[162:163], v200 offset:43008
    s_waitcnt lgkmcnt(14)
    v_mfma_f32_32x32x16_bf16 v[64:79], v[164:167], v[144:147], v[64:79]
    ds_read_b64_tr_b16 v[164:165], v201 offset:40960
    ds_read_b64_tr_b16 v[166:167], v201 offset:43008
    s_waitcnt lgkmcnt(14)
    v_mfma_f32_32x32x16_bf16 v[80:95], v[168:171], v[144:147], v[80:95]
    ds_read_b64_tr_b16 v[168:169], v202 offset:40960
    ds_read_b64_tr_b16 v[170:171], v202 offset:43008
    s_waitcnt lgkmcnt(14)
    v_mfma_f32_32x32x16_bf16 v[96:111], v[172:175], v[144:147], v[96:111]
    ds_read_b64_tr_b16 v[172:173], v203 offset:40960
    ds_read_b64_tr_b16 v[174:175], v203 offset:43008
    s_waitcnt lgkmcnt(14)
    v_mfma_f32_32x32x16_bf16 v[48:63], v[176:179], v[148:151], v[48:63]
    ds_read_b64_tr_b16 v[176:177], v200 offset:45056
    ds_read_b64_tr_b16 v[178:179], v200 offset:47104
    s_waitcnt lgkmcnt(14)
    v_mfma_f32_32x32x16_bf16 v[64:79], v[180:183], v[148:151], v[64:79]
    ds_read_b64_tr_b16 v[180:181], v201 offset:45056
    ds_read_b64_tr_b16 v[182:183], v201 offset:47104
    s_waitcnt lgkmcnt(14)
    v_mfma_f32_32x32x16_bf16 v[80:95], v[184:187], v[148:151], v[80:95]
    ds_read_b64_tr_b16 v[184:185], v202 offset:45056
    ds_read_b64_tr_b16 v[186:187], v202 offset:47104
    s_waitcnt lgkmcnt(14)
    v_mfma_f32_32x32x16_bf16 v[96:111], v[188:191], v[148:151], v[96:111]
    ds_read_b64_tr_b16 v[188:189], v203 offset:45056
    ds_read_b64_tr_b16 v[190:191], v203 offset:47104
    s_waitcnt lgkmcnt(14)
    v_mfma_f32_32x32x16_bf16 v[48:63], v[160:163], v[152:155], v[48:63]
    s_waitcnt lgkmcnt(12)
    v_mfma_f32_32x32x16_bf16 v[64:79], v[164:167], v[152:155], v[64:79]
    s_waitcnt lgkmcnt(10)
    v_mfma_f32_32x32x16_bf16 v[80:95], v[168:171], v[152:155], v[80:95]
    s_waitcnt lgkmcnt(8)
    v_mfma_f32_32x32x16_bf16 v[96:111], v[172:175], v[152:155], v[96:111]
    s_waitcnt lgkmcnt(6)
    v_mfma_f32_32x32x16_bf16 v[48:63], v[176:179], v[156:159], v[48:63]
    s_waitcnt lgkmcnt(4)
    v_mfma_f32_32x32x16_bf16 v[64:79], v[180:183], v[156:159], v[64:79]
    s_waitcnt lgkmcnt(2)
    v_mfma_f32_32x32x16_bf16 v[80:95], v[184:187], v[156:159], v[80:95]
    s_waitcnt lgkmcnt(0)
    v_mfma_f32_32x32x16_bf16 v[96:111], v[188:191], v[156:159], v[96:111]
    s_nop 11
.Lattn_kernel_skipp0:
    s_cmp_gt_u32 s35, s37
    s_cbranch_scc1 .Lattn_kernel_skip0
    s_lshl_b32 s40, s29, 1
    s_cmp_lt_u32 s35, s40
    s_cbranch_scc1 .Lattn_kernel_nomaska0
    s_lshl_b32 s40, s35, 6
    v_lshlrev_b32 v206, 2, v4
    v_add_u32 v206, s40, v206
    v_sub_u32 v208, v5, v206
    v_mov_b32 v207, 0xff800000
    v_cmp_gt_i32 vcc, 0, v208
    s_nop 1
    v_cndmask_b32 v112, v112, v207, vcc
    v_cmp_gt_i32 vcc, 1, v208
    s_nop 1
    v_cndmask_b32 v113, v113, v207, vcc
    v_cmp_gt_i32 vcc, 2, v208
    s_nop 1
    v_cndmask_b32 v114, v114, v207, vcc
    v_cmp_gt_i32 vcc, 3, v208
    s_nop 1
    v_cndmask_b32 v115, v115, v207, vcc
    v_cmp_gt_i32 vcc, 8, v208
    s_nop 1
    v_cndmask_b32 v116, v116, v207, vcc
    v_cmp_gt_i32 vcc, 9, v208
    s_nop 1
    v_cndmask_b32 v117, v117, v207, vcc
    v_cmp_gt_i32 vcc, 10, v208
    s_nop 1
    v_cndmask_b32 v118, v118, v207, vcc
    v_cmp_gt_i32 vcc, 11, v208
    s_nop 1
    v_cndmask_b32 v119, v119, v207, vcc
    v_cmp_gt_i32 vcc, 16, v208
    s_nop 1
    v_cndmask_b32 v120, v120, v207, vcc
    v_cmp_gt_i32 vcc, 17, v208
    s_nop 1
    v_cndmask_b32 v121, v121, v207, vcc
    v_cmp_gt_i32 vcc, 18, v208
    s_nop 1
    v_cndmask_b32 v122, v122, v207, vcc
    v_cmp_gt_i32 vcc, 19, v208
    s_nop 1
    v_cndmask_b32 v123, v123, v207, vcc
    v_cmp_gt_i32 vcc, 24, v208
    s_nop 1
    v_cndmask_b32 v124, v124, v207, vcc
    v_cmp_gt_i32 vcc, 25, v208
    s_nop 1
    v_cndmask_b32 v125, v125, v207, vcc
    v_cmp_gt_i32 vcc, 26, v208
    s_nop 1
    v_cndmask_b32 v126, v126, v207, vcc
    v_cmp_gt_i32 vcc, 27, v208
    s_nop 1
    v_cndmask_b32 v127, v127, v207, vcc
    v_cmp_gt_i32 vcc, 32, v208
    s_nop 1
    v_cndmask_b32 v128, v128, v207, vcc
    v_cmp_gt_i32 vcc, 33, v208
    s_nop 1
    v_cndmask_b32 v129, v129, v207, vcc
    v_cmp_gt_i32 vcc, 34, v208
    s_nop 1
    v_cndmask_b32 v130, v130, v207, vcc
    v_cmp_gt_i32 vcc, 35, v208
    s_nop 1
    v_cndmask_b32 v131, v131, v207, vcc
    v_cmp_gt_i32 vcc, 40, v208
    s_nop 1
    v_cndmask_b32 v132, v132, v207, vcc
    v_cmp_gt_i32 vcc, 41, v208
    s_nop 1
    v_cndmask_b32 v133, v133, v207, vcc
    v_cmp_gt_i32 vcc, 42, v208
    s_nop 1
    v_cndmask_b32 v134, v134, v207, vcc
    v_cmp_gt_i32 vcc, 43, v208
    s_nop 1
    v_cndmask_b32 v135, v135, v207, vcc
    v_cmp_gt_i32 vcc, 48, v208
    s_nop 1
    v_cndmask_b32 v136, v136, v207, vcc
    v_cmp_gt_i32 vcc, 49, v208
    s_nop 1
    v_cndmask_b32 v137, v137, v207, vcc
    v_cmp_gt_i32 vcc, 50, v208
    s_nop 1
    v_cndmask_b32 v138, v138, v207, vcc
    v_cmp_gt_i32 vcc, 51, v208
    s_nop 1
    v_cndmask_b32 v139, v139, v207, vcc
    v_cmp_gt_i32 vcc, 56, v208
    s_nop 1
    v_cndmask_b32 v140, v140, v207, vcc
    v_cmp_gt_i32 vcc, 57, v208
    s_nop 1
    v_cndmask_b32 v141, v141, v207, vcc
    v_cmp_gt_i32 vcc, 58, v208
    s_nop 1
    v_cndmask_b32 v142, v142, v207, vcc
    v_cmp_gt_i32 vcc, 59, v208
    s_nop 1
    v_cndmask_b32 v143, v143, v207, vcc
    s_nop 4
.Lattn_kernel_nomaska0:
    v_max3_f32 v206, v112, v113, v114
    v_max3_f32 v207, v115, v116, v117
    v_max3_f32 v206, v206, v118, v119
    v_max3_f32 v207, v207, v120, v121
    v_max3_f32 v206, v206, v122, v123
    v_max3_f32 v207, v207, v124, v125
    v_max3_f32 v206, v206, v126, v127
    v_max3_f32 v207, v207, v128, v129
    v_max3_f32 v206, v206, v130, v131
    v_max3_f32 v207, v207, v132, v133
    v_max3_f32 v206, v206, v134, v135
    v_max3_f32 v207, v207, v136, v137
    v_max3_f32 v206, v206, v138, v139
    v_max3_f32 v207, v207, v140, v141
    v_max3_f32 v206, v206, v142, v143
    v_max_f32 v206, v206, v207
    v_mov_b32 v207, v206
    s_nop 1
    v_permlane32_swap_b32 v206, v207
    v_max_f32 v206, v206, v207
    v_cmp_gt_f32 vcc, v206, v211
    s_nop 4
    s_cbranch_vccz .Lattn_kernel_noresca0
    v_max_f32 v209, v206, v204
    v_sub_f32 v210, v204, v209
    v_mul_f32 v210, s39, v210
    v_exp_f32 v210, v210
    v_mov_b32 v204, v209
    v_add_f32 v211, s42, v209
    v_mul_f32 v212, s39, v209
    v_sub_f32 v212, 0, v212
    v_mov_b32 v213, v212
    v_mul_f32 v205, v205, v210
    v_mul_f32 v48, v48, v210
    v_mul_f32 v49, v49, v210
    v_mul_f32 v50, v50, v210
    v_mul_f32 v51, v51, v210
    v_mul_f32 v52, v52, v210
    v_mul_f32 v53, v53, v210
    v_mul_f32 v54, v54, v210
    v_mul_f32 v55, v55, v210
    v_mul_f32 v56, v56, v210
    v_mul_f32 v57, v57, v210
    v_mul_f32 v58, v58, v210
    v_mul_f32 v59, v59, v210
    v_mul_f32 v60, v60, v210
    v_mul_f32 v61, v61, v210
    v_mul_f32 v62, v62, v210
    v_mul_f32 v63, v63, v210
    v_mul_f32 v64, v64, v210
    v_mul_f32 v65, v65, v210
    v_mul_f32 v66, v66, v210
    v_mul_f32 v67, v67, v210
    v_mul_f32 v68, v68, v210
    v_mul_f32 v69, v69, v210
    v_mul_f32 v70, v70, v210
    v_mul_f32 v71, v71, v210
    v_mul_f32 v72, v72, v210
    v_mul_f32 v73, v73, v210
    v_mul_f32 v74, v74, v210
    v_mul_f32 v75, v75, v210
    v_mul_f32 v76, v76, v210
    v_mul_f32 v77, v77, v210
    v_mul_f32 v78, v78, v210
    v_mul_f32 v79, v79, v210
    v_mul_f32 v80, v80, v210
    v_mul_f32 v81, v81, v210
    v_mul_f32 v82, v82, v210
    v_mul_f32 v83, v83, v210
    v_mul_f32 v84, v84, v210
    v_mul_f32 v85, v85, v210
    v_mul_f32 v86, v86, v210
    v_mul_f32 v87, v87, v210
    v_mul_f32 v88, v88, v210
    v_mul_f32 v89, v89, v210
    v_mul_f32 v90, v90, v210
    v_mul_f32 v91, v91, v210
    v_mul_f32 v92, v92, v210
    v_mul_f32 v93, v93, v210
    v_mul_f32 v94, v94, v210
    v_mul_f32 v95, v95, v210
    v_mul_f32 v96, v96, v210
    v_mul_f32 v97, v97, v210
    v_mul_f32 v98, v98, v210
    v_mul_f32 v99, v99, v210
    v_mul_f32 v100, v100, v210
    v_mul_f32 v101, v101, v210
    v_mul_f32 v102, v102, v210
    v_mul_f32 v103, v103, v210
    v_mul_f32 v104, v104, v210
    v_mul_f32 v105, v105, v210
    v_mul_f32 v106, v106, v210
    v_mul_f32 v107, v107, v210
    v_mul_f32 v108, v108, v210
    v_mul_f32 v109, v109, v210
    v_mul_f32 v110, v110, v210
    v_mul_f32 v111, v111, v210
    s_nop 4
.Lattn_kernel_noresca0:
    v_fma_f32 v112, v112, s39, v212
    v_fma_f32 v113, v113, s39, v212
    v_fma_f32 v114, v114, s39, v212
    v_fma_f32 v115, v115, s39, v212
    v_fma_f32 v116, v116, s39, v212
    v_fma_f32 v117, v117, s39, v212
    v_fma_f32 v118, v118, s39, v212
    v_fma_f32 v119, v119, s39, v212
    v_fma_f32 v120, v120, s39, v212
    v_fma_f32 v121, v121, s39, v212
    v_fma_f32 v122, v122, s39, v212
    v_fma_f32 v123, v123, s39, v212
    v_fma_f32 v124, v124, s39, v212
    v_fma_f32 v125, v125, s39, v212
    v_fma_f32 v126, v126, s39, v212
    v_fma_f32 v127, v127, s39, v212
    v_fma_f32 v128, v128, s39, v212
    v_fma_f32 v129, v129, s39, v212
    v_fma_f32 v130, v130, s39, v212
    v_fma_f32 v131, v131, s39, v212
    v_fma_f32 v132, v132, s39, v212
    v_fma_f32 v133, v133, s39, v212
    v_fma_f32 v134, v134, s39, v212
    v_fma_f32 v135, v135, s39, v212
    v_fma_f32 v136, v136, s39, v212
    v_fma_f32 v137, v137, s39, v212
    v_fma_f32 v138, v138, s39, v212
    v_fma_f32 v139, v139, s39, v212
    v_fma_f32 v140, v140, s39, v212
    v_fma_f32 v141, v141, s39, v212
    v_fma_f32 v142, v142, s39, v212
    v_fma_f32 v143, v143, s39, v212
    v_exp_f32 v112, v112
    v_exp_f32 v113, v113
    v_exp_f32 v114, v114
    v_exp_f32 v115, v115
    v_exp_f32 v116, v116
    v_exp_f32 v117, v117
    v_exp_f32 v118, v118
    v_exp_f32 v119, v119
    v_exp_f32 v120, v120
    v_exp_f32 v121, v121
    v_exp_f32 v122, v122
    v_exp_f32 v123, v123
    v_exp_f32 v124, v124
    v_exp_f32 v125, v125
    v_exp_f32 v126, v126
    v_exp_f32 v127, v127
    v_exp_f32 v128, v128
    v_exp_f32 v129, v129
    v_exp_f32 v130, v130
    v_exp_f32 v131, v131
    v_exp_f32 v132, v132
    v_exp_f32 v133, v133
    v_exp_f32 v134, v134
    v_exp_f32 v135, v135
    v_exp_f32 v136, v136
    v_exp_f32 v137, v137
    v_exp_f32 v138, v138
    v_exp_f32 v139, v139
    v_exp_f32 v140, v140
    v_exp_f32 v141, v141
    v_exp_f32 v142, v142
    v_exp_f32 v143, v143
    v_cvt_pk_bf16_f32 v144, v112, v113
    v_cvt_pk_bf16_f32 v145, v114, v115
    v_cvt_pk_bf16_f32 v146, v116, v117
    v_cvt_pk_bf16_f32 v147, v118, v119
    v_cvt_pk_bf16_f32 v148, v120, v121
    v_cvt_pk_bf16_f32 v149, v122, v123
    v_cvt_pk_bf16_f32 v150, v124, v125
    v_cvt_pk_bf16_f32 v151, v126, v127
    v_cvt_pk_bf16_f32 v152, v128, v129
    v_cvt_pk_bf16_f32 v153, v130, v131
    v_cvt_pk_bf16_f32 v154, v132, v133
    v_cvt_pk_bf16_f32 v155, v134, v135
    v_cvt_pk_bf16_f32 v156, v136, v137
    v_cvt_pk_bf16_f32 v157, v138, v139
    v_cvt_pk_bf16_f32 v158, v140, v141
    v_cvt_pk_bf16_f32 v159, v142, v143
    v_add_f32 v112, v112, v128
    v_add_f32 v113, v113, v129
    v_add_f32 v114, v114, v130
    v_add_f32 v115, v115, v131
    v_add_f32 v116, v116, v132
    v_add_f32 v117, v117, v133
    v_add_f32 v118, v118, v134
    v_add_f32 v119, v119, v135
    v_add_f32 v120, v120, v136
    v_add_f32 v121, v121, v137
    v_add_f32 v122, v122, v138
    v_add_f32 v123, v123, v139
    v_add_f32 v124, v124, v140
    v_add_f32 v125, v125, v141
    v_add_f32 v126, v126, v142
    v_add_f32 v127, v127, v143
    v_add_f32 v112, v112, v120
    v_add_f32 v113, v113, v121
    v_add_f32 v114, v114, v122
    v_add_f32 v115, v115, v123
    v_add_f32 v116, v116, v124
    v_add_f32 v117, v117, v125
    v_add_f32 v118, v118, v126
    v_add_f32 v119, v119, v127
    v_add_f32 v112, v112, v116
    v_add_f32 v113, v113, v117
    v_add_f32 v114, v114, v118
    v_add_f32 v115, v115, v119
    v_add_f32 v112, v112, v114
    v_add_f32 v113, v113, v115
    v_add_f32 v205, v205, v112
    v_add_f32 v205, v205, v113
    s_nop 4
.Lattn_kernel_skip0:
    s_add_u32 s35, s35, 2
    s_add_u32 s47, s47, 1
    s_cmp_lt_u32 s47, s34
    s_cbranch_scc0 .Lattn_kernel_g0t0
    s_waitcnt vmcnt(0)
    s_barrier
    s_cmp_gt_u32 s35, s37
    s_cbranch_scc1 .Lattn_kernel_skipd1
    ds_read_b128 v[160:163], v192 offset:32768
    ds_read_b128 v[164:167], v193 offset:32768
    ds_read_b128 v[168:171], v194 offset:32768
    ds_read_b128 v[172:175], v195 offset:32768
    ds_read_b128 v[176:179], v196 offset:32768
    ds_read_b128 v[180:183], v197 offset:32768
    ds_read_b128 v[184:187], v198 offset:32768
    ds_read_b128 v[188:191], v199 offset:32768
    s_waitcnt lgkmcnt(7)
    v_mfma_f32_32x32x16_bf16 v[112:127], v[160:163], v[16:19], 0
    s_add_u32 m0, s41, 0
    s_add_u32 s40, s36, 0
    buffer_load_dwordx4 v11, s[16:19], s40 offen lds
    ds_read_b128 v[160:163], v192 offset:40960
    s_waitcnt lgkmcnt(7)
    v_mfma_f32_32x32x16_bf16 v[112:127], v[164:167], v[20:23], v[112:127]
    s_add_u32 m0, s41, 49152
    s_add_u32 s40, s36, -32768
    buffer_load_dwordx4 v12, s[20:23], s40 offen lds
    ds_read_b128 v[164:167], v193 offset:40960
    s_waitcnt lgkmcnt(7)
    v_mfma_f32_32x32x16_bf16 v[112:127], v[168:171], v[24:27], v[112:127]
    s_add_u32 m0, s41, 65536
    s_add_u32 s40, s36, 16384
    buffer_load_dwordx4 v11, s[16:19], s40 offen lds
    ds_read_b128 v[168:171], v194 offset:40960
    s_waitcnt lgkmcnt(7)
    v_mfma_f32_32x32x16_bf16 v[112:127], v[172:175], v[28:31], v[112:127]
    s_add_u32 m0, s41, 114688
    s_add_u32 s40, s36, -16384
    buffer_load_dwordx4 v12, s[20:23], s40 offen lds
    ds_read_b128 v[172:175], v195 offset:40960
    s_waitcnt lgkmcnt(7)
    v_mfma_f32_32x32x16_bf16 v[112:127], v[176:179], v[32:35], v[112:127]
    s_add_u32 m0, s41, 4096
    s_add_u32 s40, s36, 4096
    buffer_load_dwordx4 v11, s[16:19], s40 offen lds
    ds_read_b128 v[176:179], v196 offset:40960
    s_waitcnt lgkmcnt(7)
    v_mfma_f32_32x32x16_bf16 v[112:127], v[180:183], v[36:39], v[112:127]
    s_add_u32 m0, s41, 53248
    s_add_u32 s40, s36, -28672
    buffer_load_dwordx4 v12, s[20:23], s40 offen lds
    ds_read_b128 v[180:183], v197 offset:40960
    s_waitcnt lgkmcnt(7)
    v_mfma_f32_32x32x16_bf16 v[112:127], v[184:187], v[40:43], v[112:127]
    s_add_u32 m0, s41, 69632
    s_add_u32 s40, s36, 20480
    buffer_load_dwordx4 v11, s[16:19], s40 offen lds
    ds_read_b128 v[184:187], v198 offset:40960
    s_waitcnt lgkmcnt(7)
    v_mfma_f32_32x32x16_bf16 v[112:127], v[188:191], v[44:47], v[112:127]
    s_add_u32 m0, s41, 118784
    s_add_u32 s40, s36, -12288
    buffer_load_dwordx4 v12, s[20:23], s40 offen lds
    ds_read_b128 v[188:191], v199 offset:40960
    s_waitcnt lgkmcnt(7)
    v_mfma_f32_32x32x16_bf16 v[128:143], v[160:163], v[16:19], 0
    s_add_u32 m0, s41, 8192
    s_add_u32 s40, s36, 8192
    buffer_load_dwordx4 v11, s[16:19], s40 offen lds
    s_waitcnt lgkmcnt(6)
    v_mfma_f32_32x32x16_bf16 v[128:143], v[164:167], v[20:23], v[128:143]
    s_add_u32 m0, s41, 57344
    s_add_u32 s40, s36, -24576
    buffer_load_dwordx4 v12, s[20:23], s40 offen lds
    s_waitcnt lgkmcnt(5)
    v_mfma_f32_32x32x16_bf16 v[128:143], v[168:171], v[24:27], v[128:143]
    s_add_u32 m0, s41, 73728
    s_add_u32 s40, s36, 24576
    buffer_load_dwordx4 v11, s[16:19], s40 offen lds
    s_waitcnt lgkmcnt(4)
    v_mfma_f32_32x32x16_bf16 v[128:143], v[172:175], v[28:31], v[128:143]
    s_add_u32 m0, s41, 122880
    s_add_u32 s40, s36, -8192
    buffer_load_dwordx4 v12, s[20:23], s40 offen lds
    s_waitcnt lgkmcnt(3)
    v_mfma_f32_32x32x16_bf16 v[128:143], v[176:179], v[32:35], v[128:143]
    s_add_u32 m0, s41, 12288
    s_add_u32 s40, s36, 12288
    buffer_load_dwordx4 v11, s[16:19], s40 offen lds
    s_waitcnt lgkmcnt(2)
    v_mfma_f32_32x32x16_bf16 v[128:143], v[180:183], v[36:39], v[128:143]
    s_add_u32 m0, s41, 61440
    s_add_u32 s40, s36, -20480
    buffer_load_dwordx4 v12, s[20:23], s40 offen lds
    s_waitcnt lgkmcnt(1)
    v_mfma_f32_32x32x16_bf16 v[128:143], v[184:187], v[40:43], v[128:143]
    s_add_u32 m0, s41, 77824
    s_add_u32 s40, s36, 28672
    buffer_load_dwordx4 v11, s[16:19], s40 offen lds
    s_waitcnt lgkmcnt(0)
    v_mfma_f32_32x32x16_bf16 v[128:143], v[188:191], v[44:47], v[128:143]
    s_add_u32 m0, s41, 126976
    s_add_u32 s40, s36, -4096
    buffer_load_dwordx4 v12, s[20:23], s40 offen lds
    s_add_u32 s36, s36, 32768
    s_nop 7
    s_branch .Lattn_kernel_skipq1
.Lattn_kernel_skipd1:
    s_add_u32 m0, s41, 0
    s_add_u32 s40, s36, 0
    buffer_load_dwordx4 v11, s[16:19], s40 offen lds
    s_add_u32 m0, s41, 49152
    s_add_u32 s40, s36, -32768
    buffer_load_dwordx4 v12, s[20:23], s40 offen lds
    s_add_u32 m0, s41, 65536
    s_add_u32 s40, s36, 16384
    buffer_load_dwordx4 v11, s[16:19], s40 offen lds
    s_add_u32 m0, s41, 114688
    s_add_u32 s40, s36, -16384
    buffer_load_dwordx4 v12, s[20:23], s40 offen lds
    s_add_u32 m0, s41, 4096
    s_add_u32 s40, s36, 4096
    buffer_load_dwordx4 v11, s[16:19], s40 offen lds
    s_add_u32 m0, s41, 53248
    s_add_u32 s40, s36, -28672
    buffer_load_dwordx4 v12, s[20:23], s40 offen lds
    s_add_u32 m0, s41, 69632
    s_add_u32 s40, s36, 20480
    buffer_load_dwordx4 v11, s[16:19], s40 offen lds
    s_add_u32 m0, s41, 118784
    s_add_u32 s40, s36, -12288
    buffer_load_dwordx4 v12, s[20:23], s40 offen lds
    s_add_u32 m0, s41, 8192
    s_add_u32 s40, s36, 8192
    buffer_load_dwordx4 v11, s[16:19], s40 offen lds
    s_add_u32 m0, s41, 57344
    s_add_u32 s40, s36, -24576
    buffer_load_dwordx4 v12, s[20:23], s40 offen lds
    s_add_u32 m0, s41, 73728
    s_add_u32 s40, s36, 24576
    buffer_load_dwordx4 v11, s[16:19], s40 offen lds
    s_add_u32 m0, s41, 122880
    s_add_u32 s40, s36, -8192
    buffer_load_dwordx4 v12, s[20:23], s40 offen lds
    s_add_u32 m0, s41, 12288
    s_add_u32 s40, s36, 12288
    buffer_load_dwordx4 v11, s[16:19], s40 offen lds
    s_add_u32 m0, s41, 61440
    s_add_u32 s40, s36, -20480
    buffer_load_dwordx4 v12, s[20:23], s40 offen lds
    s_add_u32 m0, s41, 77824
    s_add_u32 s40, s36, 28672
    buffer_load_dwordx4 v11, s[16:19], s40 offen lds
    s_add_u32 m0, s41, 126976
    s_add_u32 s40, s36, -4096
    buffer_load_dwordx4 v12, s[20:23], s40 offen lds
    s_add_u32 s36, s36, 32768
.Lattn_kernel_skipq1:
    s_sub_u32 s50, s35, 2
    s_cmp_eq_u32 s47, 0
    s_cbranch_scc1 .Lattn_kernel_skipp1
    s_cmp_gt_u32 s50, s37
    s_cbranch_scc1 .Lattn_kernel_skipp1
    ds_read_b64_tr_b16 v[160:161], v200 offset:0
    ds_read_b64_tr_b16 v[162:163], v200 offset:2048
    ds_read_b64_tr_b16 v[164:165], v201 offset:0
    ds_read_b64_tr_b16 v[166:167], v201 offset:2048
    ds_read_b64_tr_b16 v[168:169], v202 offset:0
    ds_read_b64_tr_b16 v[170:171], v202 offset:2048
    ds_read_b64_tr_b16 v[172:173], v203 offset:0
    ds_read_b64_tr_b16 v[174:175], v203 offset:2048
    ds_read_b64_tr_b16 v[176:177], v200 offset:4096
    ds_read_b64_tr_b16 v[178:179], v200 offset:6144
    ds_read_b64_tr_b16 v[180:181], v201 offset:4096
    ds_read_b64_tr_b16 v[182:183], v201 offset:6144
    ds_read_b64_tr_b16 v[184:185], v202 offset:4096
    ds_read_b64_tr_b16 v[186:187], v202 offset:6144
    ds_read_b64_tr_b16 v[188:189], v203 offset:4096
    ds_read_b64_tr_b16 v[190:191], v203 offset:6144
    s_waitcnt lgkmcnt(14)
    v_mfma_f32_32x32x16_bf16 v[48:63], v[160:163], v[144:147], v[48:63]
    ds_read_b64_tr_b16 v[160:161], v200 offset:8192
    ds_read_b64_tr_b16 v[162:163], v200 offset:10240
    s_waitcnt lgkmcnt(14)
    v_mfma_f32_32x32x16_bf16 v[64:79], v[164:167], v[144:147], v[64:79]
    ds_read_b64_tr_b16 v[164:165], v201 offset:8192
    ds_read_b64_tr_b16 v[166:167], v201 offset:10240
    s_waitcnt lgkmcnt(14)
    v_mfma_f32_32x32x16_bf16 v[80:95], v[168:171], v[144:147], v[80:95]
    ds_read_b64_tr_b16 v[168:169], v202 offset:8192
    ds_read_b64_tr_b16 v[170:171], v202 offset:10240
    s_waitcnt lgkmcnt(14)
    v_mfma_f32_32x32x16_bf16 v[96:111], v[172:175], v[144:147], v[96:111]
    ds_read_b64_tr_b16 v[172:173], v203 offset:8192
    ds_read_b64_tr_b16 v[174:175], v203 offset:10240
    s_waitcnt lgkmcnt(14)
    v_mfma_f32_32x32x16_bf16 v[48:63], v[176:179], v[148:151], v[48:63]
    ds_read_b64_tr_b16 v[176:177], v200 offset:12288
    ds_read_b64_tr_b16 v[178:179], v200 offset:14336
    s_waitcnt lgkmcnt(14)
    v_mfma_f32_32x32x16_bf16 v[64:79], v[180:183], v[148:151], v[64:79]
    ds_read_b64_tr_b16 v[180:181], v201 offset:12288
    ds_read_b64_tr_b16 v[182:183], v201 offset:14336
    s_waitcnt lgkmcnt(14)
    v_mfma_f32_32x32x16_bf16 v[80:95], v[184:187], v[148:151], v[80:95]
    ds_read_b64_tr_b16 v[184:185], v202 offset:12288
    ds_read_b64_tr_b16 v[186:187], v202 offset:14336
    s_waitcnt lgkmcnt(14)
    v_mfma_f32_32x32x16_bf16 v[96:111], v[188:191], v[148:151], v[96:111]
    ds_read_b64_tr_b16 v[188:189], v203 offset:12288
    ds_read_b64_tr_b16 v[190:191], v203 offset:14336
    s_waitcnt lgkmcnt(14)
    v_mfma_f32_32x32x16_bf16 v[48:63], v[160:163], v[152:155], v[48:63]
    s_waitcnt lgkmcnt(12)
    v_mfma_f32_32x32x16_bf16 v[64:79], v[164:167], v[152:155], v[64:79]
    s_waitcnt lgkmcnt(10)
    v_mfma_f32_32x32x16_bf16 v[80:95], v[168:171], v[152:155], v[80:95]
    s_waitcnt lgkmcnt(8)
    v_mfma_f32_32x32x16_bf16 v[96:111], v[172:175], v[152:155], v[96:111]
    s_waitcnt lgkmcnt(6)
    v_mfma_f32_32x32x16_bf16 v[48:63], v[176:179], v[156:159], v[48:63]
    s_waitcnt lgkmcnt(4)
    v_mfma_f32_32x32x16_bf16 v[64:79], v[180:183], v[156:159], v[64:79]
    s_waitcnt lgkmcnt(2)
    v_mfma_f32_32x32x16_bf16 v[80:95], v[184:187], v[156:159], v[80:95]
    s_waitcnt lgkmcnt(0)
    v_mfma_f32_32x32x16_bf16 v[96:111], v[188:191], v[156:159], v[96:111]
    s_nop 11
.Lattn_kernel_skipp1:
    s_cmp_gt_u32 s35, s37
    s_cbranch_scc1 .Lattn_kernel_skip1
    s_lshl_b32 s40, s29, 1
    s_cmp_lt_u32 s35, s40
    s_cbranch_scc1 .Lattn_kernel_nomaska1
    s_lshl_b32 s40, s35, 6
    v_lshlrev_b32 v206, 2, v4
    v_add_u32 v206, s40, v206
    v_sub_u32 v208, v5, v206
    v_mov_b32 v207, 0xff800000
    v_cmp_gt_i32 vcc, 0, v208
    s_nop 1
    v_cndmask_b32 v112, v112, v207, vcc
    v_cmp_gt_i32 vcc, 1, v208
    s_nop 1
    v_cndmask_b32 v113, v113, v207, vcc
    v_cmp_gt_i32 vcc, 2, v208
    s_nop 1
    v_cndmask_b32 v114, v114, v207, vcc
    v_cmp_gt_i32 vcc, 3, v208
    s_nop 1
    v_cndmask_b32 v115, v115, v207, vcc
    v_cmp_gt_i32 vcc, 8, v208
    s_nop 1
    v_cndmask_b32 v116, v116, v207, vcc
    v_cmp_gt_i32 vcc, 9, v208
    s_nop 1
    v_cndmask_b32 v117, v117, v207, vcc
    v_cmp_gt_i32 vcc, 10, v208
    s_nop 1
    v_cndmask_b32 v118, v118, v207, vcc
    v_cmp_gt_i32 vcc, 11, v208
    s_nop 1
    v_cndmask_b32 v119, v119, v207, vcc
    v_cmp_gt_i32 vcc, 16, v208
    s_nop 1
    v_cndmask_b32 v120, v120, v207, vcc
    v_cmp_gt_i32 vcc, 17, v208
    s_nop 1
    v_cndmask_b32 v121, v121, v207, vcc
    v_cmp_gt_i32 vcc, 18, v208
    s_nop 1
    v_cndmask_b32 v122, v122, v207, vcc
    v_cmp_gt_i32 vcc, 19, v208
    s_nop 1
    v_cndmask_b32 v123, v123, v207, vcc
    v_cmp_gt_i32 vcc, 24, v208
    s_nop 1
    v_cndmask_b32 v124, v124, v207, vcc
    v_cmp_gt_i32 vcc, 25, v208
    s_nop 1
    v_cndmask_b32 v125, v125, v207, vcc
    v_cmp_gt_i32 vcc, 26, v208
    s_nop 1
    v_cndmask_b32 v126, v126, v207, vcc
    v_cmp_gt_i32 vcc, 27, v208
    s_nop 1
    v_cndmask_b32 v127, v127, v207, vcc
    v_cmp_gt_i32 vcc, 32, v208
    s_nop 1
    v_cndmask_b32 v128, v128, v207, vcc
    v_cmp_gt_i32 vcc, 33, v208
    s_nop 1
    v_cndmask_b32 v129, v129, v207, vcc
    v_cmp_gt_i32 vcc, 34, v208
    s_nop 1
    v_cndmask_b32 v130, v130, v207, vcc
    v_cmp_gt_i32 vcc, 35, v208
    s_nop 1
    v_cndmask_b32 v131, v131, v207, vcc
    v_cmp_gt_i32 vcc, 40, v208
    s_nop 1
    v_cndmask_b32 v132, v132, v207, vcc
    v_cmp_gt_i32 vcc, 41, v208
    s_nop 1
    v_cndmask_b32 v133, v133, v207, vcc
    v_cmp_gt_i32 vcc, 42, v208
    s_nop 1
    v_cndmask_b32 v134, v134, v207, vcc
    v_cmp_gt_i32 vcc, 43, v208
    s_nop 1
    v_cndmask_b32 v135, v135, v207, vcc
    v_cmp_gt_i32 vcc, 48, v208
    s_nop 1
    v_cndmask_b32 v136, v136, v207, vcc
    v_cmp_gt_i32 vcc, 49, v208
    s_nop 1
    v_cndmask_b32 v137, v137, v207, vcc
    v_cmp_gt_i32 vcc, 50, v208
    s_nop 1
    v_cndmask_b32 v138, v138, v207, vcc
    v_cmp_gt_i32 vcc, 51, v208
    s_nop 1
    v_cndmask_b32 v139, v139, v207, vcc
    v_cmp_gt_i32 vcc, 56, v208
    s_nop 1
    v_cndmask_b32 v140, v140, v207, vcc
    v_cmp_gt_i32 vcc, 57, v208
    s_nop 1
    v_cndmask_b32 v141, v141, v207, vcc
    v_cmp_gt_i32 vcc, 58, v208
    s_nop 1
    v_cndmask_b32 v142, v142, v207, vcc
    v_cmp_gt_i32 vcc, 59, v208
    s_nop 1
    v_cndmask_b32 v143, v143, v207, vcc
    s_nop 4
.Lattn_kernel_nomaska1:
    v_max3_f32 v206, v112, v113, v114
    v_max3_f32 v207, v115, v116, v117
    v_max3_f32 v206, v206, v118, v119
    v_max3_f32 v207, v207, v120, v121
    v_max3_f32 v206, v206, v122, v123
    v_max3_f32 v207, v207, v124, v125
    v_max3_f32 v206, v206, v126, v127
    v_max3_f32 v207, v207, v128, v129
    v_max3_f32 v206, v206, v130, v131
    v_max3_f32 v207, v207, v132, v133
    v_max3_f32 v206, v206, v134, v135
    v_max3_f32 v207, v207, v136, v137
    v_max3_f32 v206, v206, v138, v139
    v_max3_f32 v207, v207, v140, v141
    v_max3_f32 v206, v206, v142, v143
    v_max_f32 v206, v206, v207
    v_mov_b32 v207, v206
    s_nop 1
    v_permlane32_swap_b32 v206, v207
    v_max_f32 v206, v206, v207
    v_cmp_gt_f32 vcc, v206, v211
    s_nop 4
    s_cbranch_vccz .Lattn_kernel_noresca1
    v_max_f32 v209, v206, v204
    v_sub_f32 v210, v204, v209
    v_mul_f32 v210, s39, v210
    v_exp_f32 v210, v210
    v_mov_b32 v204, v209
    v_add_f32 v211, s42, v209
    v_mul_f32 v212, s39, v209
    v_sub_f32 v212, 0, v212
    v_mov_b32 v213, v212
    v_mul_f32 v205, v205, v210
    v_mul_f32 v48, v48, v210
    v_mul_f32 v49, v49, v210
    v_mul_f32 v50, v50, v210
    v_mul_f32 v51, v51, v210
    v_mul_f32 v52, v52, v210
    v_mul_f32 v53, v53, v210
    v_mul_f32 v54, v54, v210
    v_mul_f32 v55, v55, v210
    v_mul_f32 v56, v56, v210
    v_mul_f32 v57, v57, v210
    v_mul_f32 v58, v58, v210
    v_mul_f32 v59, v59, v210
    v_mul_f32 v60, v60, v210
    v_mul_f32 v61, v61, v210
    v_mul_f32 v62, v62, v210
    v_mul_f32 v63, v63, v210
    v_mul_f32 v64, v64, v210
    v_mul_f32 v65, v65, v210
    v_mul_f32 v66, v66, v210
    v_mul_f32 v67, v67, v210
    v_mul_f32 v68, v68, v210
    v_mul_f32 v69, v69, v210
    v_mul_f32 v70, v70, v210
    v_mul_f32 v71, v71, v210
    v_mul_f32 v72, v72, v210
    v_mul_f32 v73, v73, v210
    v_mul_f32 v74, v74, v210
    v_mul_f32 v75, v75, v210
    v_mul_f32 v76, v76, v210
    v_mul_f32 v77, v77, v210
    v_mul_f32 v78, v78, v210
    v_mul_f32 v79, v79, v210
    v_mul_f32 v80, v80, v210
    v_mul_f32 v81, v81, v210
    v_mul_f32 v82, v82, v210
    v_mul_f32 v83, v83, v210
    v_mul_f32 v84, v84, v210
    v_mul_f32 v85, v85, v210
    v_mul_f32 v86, v86, v210
    v_mul_f32 v87, v87, v210
    v_mul_f32 v88, v88, v210
    v_mul_f32 v89, v89, v210
    v_mul_f32 v90, v90, v210
    v_mul_f32 v91, v91, v210
    v_mul_f32 v92, v92, v210
    v_mul_f32 v93, v93, v210
    v_mul_f32 v94, v94, v210
    v_mul_f32 v95, v95, v210
    v_mul_f32 v96, v96, v210
    v_mul_f32 v97, v97, v210
    v_mul_f32 v98, v98, v210
    v_mul_f32 v99, v99, v210
    v_mul_f32 v100, v100, v210
    v_mul_f32 v101, v101, v210
    v_mul_f32 v102, v102, v210
    v_mul_f32 v103, v103, v210
    v_mul_f32 v104, v104, v210
    v_mul_f32 v105, v105, v210
    v_mul_f32 v106, v106, v210
    v_mul_f32 v107, v107, v210
    v_mul_f32 v108, v108, v210
    v_mul_f32 v109, v109, v210
    v_mul_f32 v110, v110, v210
    v_mul_f32 v111, v111, v210
    s_nop 4
.Lattn_kernel_noresca1:
    v_fma_f32 v112, v112, s39, v212
    v_fma_f32 v113, v113, s39, v212
    v_fma_f32 v114, v114, s39, v212
    v_fma_f32 v115, v115, s39, v212
    v_fma_f32 v116, v116, s39, v212
    v_fma_f32 v117, v117, s39, v212
    v_fma_f32 v118, v118, s39, v212
    v_fma_f32 v119, v119, s39, v212
    v_fma_f32 v120, v120, s39, v212
    v_fma_f32 v121, v121, s39, v212
    v_fma_f32 v122, v122, s39, v212
    v_fma_f32 v123, v123, s39, v212
    v_fma_f32 v124, v124, s39, v212
    v_fma_f32 v125, v125, s39, v212
    v_fma_f32 v126, v126, s39, v212
    v_fma_f32 v127, v127, s39, v212
    v_fma_f32 v128, v128, s39, v212
    v_fma_f32 v129, v129, s39, v212
    v_fma_f32 v130, v130, s39, v212
    v_fma_f32 v131, v131, s39, v212
    v_fma_f32 v132, v132, s39, v212
    v_fma_f32 v133, v133, s39, v212
    v_fma_f32 v134, v134, s39, v212
    v_fma_f32 v135, v135, s39, v212
    v_fma_f32 v136, v136, s39, v212
    v_fma_f32 v137, v137, s39, v212
    v_fma_f32 v138, v138, s39, v212
    v_fma_f32 v139, v139, s39, v212
    v_fma_f32 v140, v140, s39, v212
    v_fma_f32 v141, v141, s39, v212
    v_fma_f32 v142, v142, s39, v212
    v_fma_f32 v143, v143, s39, v212
    v_exp_f32 v112, v112
    v_exp_f32 v113, v113
    v_exp_f32 v114, v114
    v_exp_f32 v115, v115
    v_exp_f32 v116, v116
    v_exp_f32 v117, v117
    v_exp_f32 v118, v118
    v_exp_f32 v119, v119
    v_exp_f32 v120, v120
    v_exp_f32 v121, v121
    v_exp_f32 v122, v122
    v_exp_f32 v123, v123
    v_exp_f32 v124, v124
    v_exp_f32 v125, v125
    v_exp_f32 v126, v126
    v_exp_f32 v127, v127
    v_exp_f32 v128, v128
    v_exp_f32 v129, v129
    v_exp_f32 v130, v130
    v_exp_f32 v131, v131
    v_exp_f32 v132, v132
    v_exp_f32 v133, v133
    v_exp_f32 v134, v134
    v_exp_f32 v135, v135
    v_exp_f32 v136, v136
    v_exp_f32 v137, v137
    v_exp_f32 v138, v138
    v_exp_f32 v139, v139
    v_exp_f32 v140, v140
    v_exp_f32 v141, v141
    v_exp_f32 v142, v142
    v_exp_f32 v143, v143
    v_cvt_pk_bf16_f32 v144, v112, v113
    v_cvt_pk_bf16_f32 v145, v114, v115
    v_cvt_pk_bf16_f32 v146, v116, v117
    v_cvt_pk_bf16_f32 v147, v118, v119
    v_cvt_pk_bf16_f32 v148, v120, v121
    v_cvt_pk_bf16_f32 v149, v122, v123
    v_cvt_pk_bf16_f32 v150, v124, v125
    v_cvt_pk_bf16_f32 v151, v126, v127
    v_cvt_pk_bf16_f32 v152, v128, v129
    v_cvt_pk_bf16_f32 v153, v130, v131
    v_cvt_pk_bf16_f32 v154, v132, v133
    v_cvt_pk_bf16_f32 v155, v134, v135
    v_cvt_pk_bf16_f32 v156, v136, v137
    v_cvt_pk_bf16_f32 v157, v138, v139
    v_cvt_pk_bf16_f32 v158, v140, v141
    v_cvt_pk_bf16_f32 v159, v142, v143
    v_add_f32 v112, v112, v128
    v_add_f32 v113, v113, v129
    v_add_f32 v114, v114, v130
    v_add_f32 v115, v115, v131
    v_add_f32 v116, v116, v132
    v_add_f32 v117, v117, v133
    v_add_f32 v118, v118, v134
    v_add_f32 v119, v119, v135
    v_add_f32 v120, v120, v136
    v_add_f32 v121, v121, v137
    v_add_f32 v122, v122, v138
    v_add_f32 v123, v123, v139
    v_add_f32 v124, v124, v140
    v_add_f32 v125, v125, v141
    v_add_f32 v126, v126, v142
    v_add_f32 v127, v127, v143
    v_add_f32 v112, v112, v120
    v_add_f32 v113, v113, v121
    v_add_f32 v114, v114, v122
    v_add_f32 v115, v115, v123
    v_add_f32 v116, v116, v124
    v_add_f32 v117, v117, v125
    v_add_f32 v118, v118, v126
    v_add_f32 v119, v119, v127
    v_add_f32 v112, v112, v116
    v_add_f32 v113, v113, v117
    v_add_f32 v114, v114, v118
    v_add_f32 v115, v115, v119
    v_add_f32 v112, v112, v114
    v_add_f32 v113, v113, v115
    v_add_f32 v205, v205, v112
    v_add_f32 v205, v205, v113
    s_nop 4
.Lattn_kernel_skip1:
    s_add_u32 s35, s35, 2
    s_add_u32 s47, s47, 1
    s_cmp_lt_u32 s47, s34
    s_cbranch_scc1 .Lattn_kernel_loop
.Lattn_kernel_g0t1:
    s_waitcnt vmcnt(0)
    s_barrier
    s_sub_u32 s50, s35, 2
    s_cmp_gt_u32 s50, s37
    s_cbranch_scc1 .Lattn_kernel_done
    ds_read_b64_tr_b16 v[160:161], v200 offset:32768
    ds_read_b64_tr_b16 v[162:163], v200 offset:34816
    ds_read_b64_tr_b16 v[164:165], v201 offset:32768
    ds_read_b64_tr_b16 v[166:167], v201 offset:34816
    ds_read_b64_tr_b16 v[168:169], v202 offset:32768
    ds_read_b64_tr_b16 v[170:171], v202 offset:34816
    ds_read_b64_tr_b16 v[172:173], v203 offset:32768
    ds_read_b64_tr_b16 v[174:175], v203 offset:34816
    ds_read_b64_tr_b16 v[176:177], v200 offset:36864
    ds_read_b64_tr_b16 v[178:179], v200 offset:38912
    ds_read_b64_tr_b16 v[180:181], v201 offset:36864
    ds_read_b64_tr_b16 v[182:183], v201 offset:38912
    ds_read_b64_tr_b16 v[184:185], v202 offset:36864
    ds_read_b64_tr_b16 v[186:187], v202 offset:38912
    ds_read_b64_tr_b16 v[188:189], v203 offset:36864
    ds_read_b64_tr_b16 v[190:191], v203 offset:38912
    s_waitcnt lgkmcnt(14)
    v_mfma_f32_32x32x16_bf16 v[48:63], v[160:163], v[144:147], v[48:63]
    ds_read_b64_tr_b16 v[160:161], v200 offset:40960
    ds_read_b64_tr_b16 v[162:163], v200 offset:43008
    s_waitcnt lgkmcnt(14)
    v_mfma_f32_32x32x16_bf16 v[64:79], v[164:167], v[144:147], v[64:79]
    ds_read_b64_tr_b16 v[164:165], v201 offset:40960
    ds_read_b64_tr_b16 v[166:167], v201 offset:43008
    s_waitcnt lgkmcnt(14)
    v_mfma_f32_32x32x16_bf16 v[80:95], v[168:171], v[144:147], v[80:95]
    ds_read_b64_tr_b16 v[168:169], v202 offset:40960
    ds_read_b64_tr_b16 v[170:171], v202 offset:43008
    s_waitcnt lgkmcnt(14)
    v_mfma_f32_32x32x16_bf16 v[96:111], v[172:175], v[144:147], v[96:111]
    ds_read_b64_tr_b16 v[172:173], v203 offset:40960
    ds_read_b64_tr_b16 v[174:175], v203 offset:43008
    s_waitcnt lgkmcnt(14)
    v_mfma_f32_32x32x16_bf16 v[48:63], v[176:179], v[148:151], v[48:63]
    ds_read_b64_tr_b16 v[176:177], v200 offset:45056
    ds_read_b64_tr_b16 v[178:179], v200 offset:47104
    s_waitcnt lgkmcnt(14)
    v_mfma_f32_32x32x16_bf16 v[64:79], v[180:183], v[148:151], v[64:79]
    ds_read_b64_tr_b16 v[180:181], v201 offset:45056
    ds_read_b64_tr_b16 v[182:183], v201 offset:47104
    s_waitcnt lgkmcnt(14)
    v_mfma_f32_32x32x16_bf16 v[80:95], v[184:187], v[148:151], v[80:95]
    ds_read_b64_tr_b16 v[184:185], v202 offset:45056
    ds_read_b64_tr_b16 v[186:187], v202 offset:47104
    s_waitcnt lgkmcnt(14)
    v_mfma_f32_32x32x16_bf16 v[96:111], v[188:191], v[148:151], v[96:111]
    ds_read_b64_tr_b16 v[188:189], v203 offset:45056
    ds_read_b64_tr_b16 v[190:191], v203 offset:47104
    s_waitcnt lgkmcnt(14)
    v_mfma_f32_32x32x16_bf16 v[48:63], v[160:163], v[152:155], v[48:63]
    s_waitcnt lgkmcnt(12)
    v_mfma_f32_32x32x16_bf16 v[64:79], v[164:167], v[152:155], v[64:79]
    s_waitcnt lgkmcnt(10)
    v_mfma_f32_32x32x16_bf16 v[80:95], v[168:171], v[152:155], v[80:95]
    s_waitcnt lgkmcnt(8)
    v_mfma_f32_32x32x16_bf16 v[96:111], v[172:175], v[152:155], v[96:111]
    s_waitcnt lgkmcnt(6)
    v_mfma_f32_32x32x16_bf16 v[48:63], v[176:179], v[156:159], v[48:63]
    s_waitcnt lgkmcnt(4)
    v_mfma_f32_32x32x16_bf16 v[64:79], v[180:183], v[156:159], v[64:79]
    s_waitcnt lgkmcnt(2)
    v_mfma_f32_32x32x16_bf16 v[80:95], v[184:187], v[156:159], v[80:95]
    s_waitcnt lgkmcnt(0)
    v_mfma_f32_32x32x16_bf16 v[96:111], v[188:191], v[156:159], v[96:111]
    s_nop 11
    s_branch .Lattn_kernel_done
.Lattn_kernel_g0t0:
    s_waitcnt vmcnt(0)
    s_barrier
    s_sub_u32 s50, s35, 2
    s_cmp_gt_u32 s50, s37
    s_cbranch_scc1 .Lattn_kernel_done
    ds_read_b64_tr_b16 v[160:161], v200 offset:0
    ds_read_b64_tr_b16 v[162:163], v200 offset:2048
    ds_read_b64_tr_b16 v[164:165], v201 offset:0
    ds_read_b64_tr_b16 v[166:167], v201 offset:2048
    ds_read_b64_tr_b16 v[168:169], v202 offset:0
    ds_read_b64_tr_b16 v[170:171], v202 offset:2048
    ds_read_b64_tr_b16 v[172:173], v203 offset:0
    ds_read_b64_tr_b16 v[174:175], v203 offset:2048
    ds_read_b64_tr_b16 v[176:177], v200 offset:4096
    ds_read_b64_tr_b16 v[178:179], v200 offset:6144
    ds_read_b64_tr_b16 v[180:181], v201 offset:4096
    ds_read_b64_tr_b16 v[182:183], v201 offset:6144
    ds_read_b64_tr_b16 v[184:185], v202 offset:4096
    ds_read_b64_tr_b16 v[186:187], v202 offset:6144
    ds_read_b64_tr_b16 v[188:189], v203 offset:4096
    ds_read_b64_tr_b16 v[190:191], v203 offset:6144
    s_waitcnt lgkmcnt(14)
    v_mfma_f32_32x32x16_bf16 v[48:63], v[160:163], v[144:147], v[48:63]
    ds_read_b64_tr_b16 v[160:161], v200 offset:8192
    ds_read_b64_tr_b16 v[162:163], v200 offset:10240
    s_waitcnt lgkmcnt(14)
    v_mfma_f32_32x32x16_bf16 v[64:79], v[164:167], v[144:147], v[64:79]
    ds_read_b64_tr_b16 v[164:165], v201 offset:8192
    ds_read_b64_tr_b16 v[166:167], v201 offset:10240
    s_waitcnt lgkmcnt(14)
    v_mfma_f32_32x32x16_bf16 v[80:95], v[168:171], v[144:147], v[80:95]
    ds_read_b64_tr_b16 v[168:169], v202 offset:8192
    ds_read_b64_tr_b16 v[170:171], v202 offset:10240
    s_waitcnt lgkmcnt(14)
    v_mfma_f32_32x32x16_bf16 v[96:111], v[172:175], v[144:147], v[96:111]
    ds_read_b64_tr_b16 v[172:173], v203 offset:8192
    ds_read_b64_tr_b16 v[174:175], v203 offset:10240
    s_waitcnt lgkmcnt(14)
    v_mfma_f32_32x32x16_bf16 v[48:63], v[176:179], v[148:151], v[48:63]
    ds_read_b64_tr_b16 v[176:177], v200 offset:12288
    ds_read_b64_tr_b16 v[178:179], v200 offset:14336
    s_waitcnt lgkmcnt(14)
    v_mfma_f32_32x32x16_bf16 v[64:79], v[180:183], v[148:151], v[64:79]
    ds_read_b64_tr_b16 v[180:181], v201 offset:12288
    ds_read_b64_tr_b16 v[182:183], v201 offset:14336
    s_waitcnt lgkmcnt(14)
    v_mfma_f32_32x32x16_bf16 v[80:95], v[184:187], v[148:151], v[80:95]
    ds_read_b64_tr_b16 v[184:185], v202 offset:12288
    ds_read_b64_tr_b16 v[186:187], v202 offset:14336
    s_waitcnt lgkmcnt(14)
    v_mfma_f32_32x32x16_bf16 v[96:111], v[188:191], v[148:151], v[96:111]
    ds_read_b64_tr_b16 v[188:189], v203 offset:12288
    ds_read_b64_tr_b16 v[190:191], v203 offset:14336
    s_waitcnt lgkmcnt(14)
    v_mfma_f32_32x32x16_bf16 v[48:63], v[160:163], v[152:155], v[48:63]
    s_waitcnt lgkmcnt(12)
    v_mfma_f32_32x32x16_bf16 v[64:79], v[164:167], v[152:155], v[64:79]
    s_waitcnt lgkmcnt(10)
    v_mfma_f32_32x32x16_bf16 v[80:95], v[168:171], v[152:155], v[80:95]
    s_waitcnt lgkmcnt(8)
    v_mfma_f32_32x32x16_bf16 v[96:111], v[172:175], v[152:155], v[96:111]
    s_waitcnt lgkmcnt(6)
    v_mfma_f32_32x32x16_bf16 v[48:63], v[176:179], v[156:159], v[48:63]
    s_waitcnt lgkmcnt(4)
    v_mfma_f32_32x32x16_bf16 v[64:79], v[180:183], v[156:159], v[64:79]
    s_waitcnt lgkmcnt(2)
    v_mfma_f32_32x32x16_bf16 v[80:95], v[184:187], v[156:159], v[80:95]
    s_waitcnt lgkmcnt(0)
    v_mfma_f32_32x32x16_bf16 v[96:111], v[188:191], v[156:159], v[96:111]
    s_nop 11
    s_branch .Lattn_kernel_done
.Lattn_kernel_g1pre:
.Lattn_kernel_g1loop:
    s_barrier
    s_sub_u32 s50, s35, 2
    s_cmp_eq_u32 s47, 0
    s_cbranch_scc1 .Lattn_kernel_g1s0
    s_cmp_gt_u32 s50, s37
    s_cbranch_scc1 .Lattn_kernel_g1s0
    s_lshl_b32 s40, s29, 1
    s_cmp_lt_u32 s50, s40
    s_cbranch_scc1 .Lattn_kernel_nomaskb0
    s_lshl_b32 s40, s50, 6
    v_lshlrev_b32 v206, 2, v4
    v_add_u32 v206, s40, v206
    v_sub_u32 v208, v5, v206
    v_mov_b32 v207, 0xff800000
    v_cmp_gt_i32 vcc, 0, v208
    s_nop 1
    v_cndmask_b32 v112, v112, v207, vcc
    v_cmp_gt_i32 vcc, 1, v208
    s_nop 1
    v_cndmask_b32 v113, v113, v207, vcc
    v_cmp_gt_i32 vcc, 2, v208
    s_nop 1
    v_cndmask_b32 v114, v114, v207, vcc
    v_cmp_gt_i32 vcc, 3, v208
    s_nop 1
    v_cndmask_b32 v115, v115, v207, vcc
    v_cmp_gt_i32 vcc, 8, v208
    s_nop 1
    v_cndmask_b32 v116, v116, v207, vcc
    v_cmp_gt_i32 vcc, 9, v208
    s_nop 1
    v_cndmask_b32 v117, v117, v207, vcc
    v_cmp_gt_i32 vcc, 10, v208
    s_nop 1
    v_cndmask_b32 v118, v118, v207, vcc
    v_cmp_gt_i32 vcc, 11, v208
    s_nop 1
    v_cndmask_b32 v119, v119, v207, vcc
    v_cmp_gt_i32 vcc, 16, v208
    s_nop 1
    v_cndmask_b32 v120, v120, v207, vcc
    v_cmp_gt_i32 vcc, 17, v208
    s_nop 1
    v_cndmask_b32 v121, v121, v207, vcc
    v_cmp_gt_i32 vcc, 18, v208
    s_nop 1
    v_cndmask_b32 v122, v122, v207, vcc
    v_cmp_gt_i32 vcc, 19, v208
    s_nop 1
    v_cndmask_b32 v123, v123, v207, vcc
    v_cmp_gt_i32 vcc, 24, v208
    s_nop 1
    v_cndmask_b32 v124, v124, v207, vcc
    v_cmp_gt_i32 vcc, 25, v208
    s_nop 1
    v_cndmask_b32 v125, v125, v207, vcc
    v_cmp_gt_i32 vcc, 26, v208
    s_nop 1
    v_cndmask_b32 v126, v126, v207, vcc
    v_cmp_gt_i32 vcc, 27, v208
    s_nop 1
    v_cndmask_b32 v127, v127, v207, vcc
    v_cmp_gt_i32 vcc, 32, v208
    s_nop 1
    v_cndmask_b32 v128, v128, v207, vcc
    v_cmp_gt_i32 vcc, 33, v208
    s_nop 1
    v_cndmask_b32 v129, v129, v207, vcc
    v_cmp_gt_i32 vcc, 34, v208
    s_nop 1
    v_cndmask_b32 v130, v130, v207, vcc
    v_cmp_gt_i32 vcc, 35, v208
    s_nop 1
    v_cndmask_b32 v131, v131, v207, vcc
    v_cmp_gt_i32 vcc, 40, v208
    s_nop 1
    v_cndmask_b32 v132, v132, v207, vcc
    v_cmp_gt_i32 vcc, 41, v208
    s_nop 1
    v_cndmask_b32 v133, v133, v207, vcc
    v_cmp_gt_i32 vcc, 42, v208
    s_nop 1
    v_cndmask_b32 v134, v134, v207, vcc
    v_cmp_gt_i32 vcc, 43, v208
    s_nop 1
    v_cndmask_b32 v135, v135, v207, vcc
    v_cmp_gt_i32 vcc, 48, v208
    s_nop 1
    v_cndmask_b32 v136, v136, v207, vcc
    v_cmp_gt_i32 vcc, 49, v208
    s_nop 1
    v_cndmask_b32 v137, v137, v207, vcc
    v_cmp_gt_i32 vcc, 50, v208
    s_nop 1
    v_cndmask_b32 v138, v138, v207, vcc
    v_cmp_gt_i32 vcc, 51, v208
    s_nop 1
    v_cndmask_b32 v139, v139, v207, vcc
    v_cmp_gt_i32 vcc, 56, v208
    s_nop 1
    v_cndmask_b32 v140, v140, v207, vcc
    v_cmp_gt_i32 vcc, 57, v208
    s_nop 1
    v_cndmask_b32 v141, v141, v207, vcc
    v_cmp_gt_i32 vcc, 58, v208
    s_nop 1
    v_cndmask_b32 v142, v142, v207, vcc
    v_cmp_gt_i32 vcc, 59, v208
    s_nop 1
    v_cndmask_b32 v143, v143, v207, vcc
    s_nop 4
.Lattn_kernel_nomaskb0:
    v_max3_f32 v206, v112, v113, v114
    v_max3_f32 v207, v115, v116, v117
    v_max3_f32 v206, v206, v118, v119
    v_max3_f32 v207, v207, v120, v121
    v_max3_f32 v206, v206, v122, v123
    v_max3_f32 v207, v207, v124, v125
    v_max3_f32 v206, v206, v126, v127
    v_max3_f32 v207, v207, v128, v129
    v_max3_f32 v206, v206, v130, v131
    v_max3_f32 v207, v207, v132, v133
    v_max3_f32 v206, v206, v134, v135
    v_max3_f32 v207, v207, v136, v137
    v_max3_f32 v206, v206, v138, v139
    v_max3_f32 v207, v207, v140, v141
    v_max3_f32 v206, v206, v142, v143
    v_max_f32 v206, v206, v207
    v_mov_b32 v207, v206
    s_nop 1
    v_permlane32_swap_b32 v206, v207
    v_max_f32 v206, v206, v207
    v_cmp_gt_f32 vcc, v206, v211
    s_nop 4
    s_cbranch_vccz .Lattn_kernel_norescb0
    v_max_f32 v209, v206, v204
    v_sub_f32 v210, v204, v209
    v_mul_f32 v210, s39, v210
    v_exp_f32 v210, v210
    v_mov_b32 v204, v209
    v_add_f32 v211, s42, v209
    v_mul_f32 v212, s39, v209
    v_sub_f32 v212, 0, v212
    v_mov_b32 v213, v212
    v_mul_f32 v205, v205, v210
    v_mul_f32 v48, v48, v210
    v_mul_f32 v49, v49, v210
    v_mul_f32 v50, v50, v210
    v_mul_f32 v51, v51, v210
    v_mul_f32 v52, v52, v210
    v_mul_f32 v53, v53, v210
    v_mul_f32 v54, v54, v210
    v_mul_f32 v55, v55, v210
    v_mul_f32 v56, v56, v210
    v_mul_f32 v57, v57, v210
    v_mul_f32 v58, v58, v210
    v_mul_f32 v59, v59, v210
    v_mul_f32 v60, v60, v210
    v_mul_f32 v61, v61, v210
    v_mul_f32 v62, v62, v210
    v_mul_f32 v63, v63, v210
    v_mul_f32 v64, v64, v210
    v_mul_f32 v65, v65, v210
    v_mul_f32 v66, v66, v210
    v_mul_f32 v67, v67, v210
    v_mul_f32 v68, v68, v210
    v_mul_f32 v69, v69, v210
    v_mul_f32 v70, v70, v210
    v_mul_f32 v71, v71, v210
    v_mul_f32 v72, v72, v210
    v_mul_f32 v73, v73, v210
    v_mul_f32 v74, v74, v210
    v_mul_f32 v75, v75, v210
    v_mul_f32 v76, v76, v210
    v_mul_f32 v77, v77, v210
    v_mul_f32 v78, v78, v210
    v_mul_f32 v79, v79, v210
    v_mul_f32 v80, v80, v210
    v_mul_f32 v81, v81, v210
    v_mul_f32 v82, v82, v210
    v_mul_f32 v83, v83, v210
    v_mul_f32 v84, v84, v210
    v_mul_f32 v85, v85, v210
    v_mul_f32 v86, v86, v210
    v_mul_f32 v87, v87, v210
    v_mul_f32 v88, v88, v210
    v_mul_f32 v89, v89, v210
    v_mul_f32 v90, v90, v210
    v_mul_f32 v91, v91, v210
    v_mul_f32 v92, v92, v210
    v_mul_f32 v93, v93, v210
    v_mul_f32 v94, v94, v210
    v_mul_f32 v95, v95, v210
    v_mul_f32 v96, v96, v210
    v_mul_f32 v97, v97, v210
    v_mul_f32 v98, v98, v210
    v_mul_f32 v99, v99, v210
    v_mul_f32 v100, v100, v210
    v_mul_f32 v101, v101, v210
    v_mul_f32 v102, v102, v210
    v_mul_f32 v103, v103, v210
    v_mul_f32 v104, v104, v210
    v_mul_f32 v105, v105, v210
    v_mul_f32 v106, v106, v210
    v_mul_f32 v107, v107, v210
    v_mul_f32 v108, v108, v210
    v_mul_f32 v109, v109, v210
    v_mul_f32 v110, v110, v210
    v_mul_f32 v111, v111, v210
    s_nop 4
.Lattn_kernel_norescb0:
    v_fma_f32 v112, v112, s39, v212
    v_fma_f32 v113, v113, s39, v212
    v_fma_f32 v114, v114, s39, v212
    v_fma_f32 v115, v115, s39, v212
    v_fma_f32 v116, v116, s39, v212
    v_fma_f32 v117, v117, s39, v212
    v_fma_f32 v118, v118, s39, v212
    v_fma_f32 v119, v119, s39, v212
    v_fma_f32 v120, v120, s39, v212
    v_fma_f32 v121, v121, s39, v212
    v_fma_f32 v122, v122, s39, v212
    v_fma_f32 v123, v123, s39, v212
    v_fma_f32 v124, v124, s39, v212
    v_fma_f32 v125, v125, s39, v212
    v_fma_f32 v126, v126, s39, v212
    v_fma_f32 v127, v127, s39, v212
    v_fma_f32 v128, v128, s39, v212
    v_fma_f32 v129, v129, s39, v212
    v_fma_f32 v130, v130, s39, v212
    v_fma_f32 v131, v131, s39, v212
    v_fma_f32 v132, v132, s39, v212
    v_fma_f32 v133, v133, s39, v212
    v_fma_f32 v134, v134, s39, v212
    v_fma_f32 v135, v135, s39, v212
    v_fma_f32 v136, v136, s39, v212
    v_fma_f32 v137, v137, s39, v212
    v_fma_f32 v138, v138, s39, v212
    v_fma_f32 v139, v139, s39, v212
    v_fma_f32 v140, v140, s39, v212
    v_fma_f32 v141, v141, s39, v212
    v_fma_f32 v142, v142, s39, v212
    v_fma_f32 v143, v143, s39, v212
    v_exp_f32 v112, v112
    v_exp_f32 v113, v113
    v_exp_f32 v114, v114
    v_exp_f32 v115, v115
    v_exp_f32 v116, v116
    v_exp_f32 v117, v117
    v_exp_f32 v118, v118
    v_exp_f32 v119, v119
    v_exp_f32 v120, v120
    v_exp_f32 v121, v121
    v_exp_f32 v122, v122
    v_exp_f32 v123, v123
    v_exp_f32 v124, v124
    v_exp_f32 v125, v125
    v_exp_f32 v126, v126
    v_exp_f32 v127, v127
    v_exp_f32 v128, v128
    v_exp_f32 v129, v129
    v_exp_f32 v130, v130
    v_exp_f32 v131, v131
    v_exp_f32 v132, v132
    v_exp_f32 v133, v133
    v_exp_f32 v134, v134
    v_exp_f32 v135, v135
    v_exp_f32 v136, v136
    v_exp_f32 v137, v137
    v_exp_f32 v138, v138
    v_exp_f32 v139, v139
    v_exp_f32 v140, v140
    v_exp_f32 v141, v141
    v_exp_f32 v142, v142
    v_exp_f32 v143, v143
    v_cvt_pk_bf16_f32 v144, v112, v113
    v_cvt_pk_bf16_f32 v145, v114, v115
    v_cvt_pk_bf16_f32 v146, v116, v117
    v_cvt_pk_bf16_f32 v147, v118, v119
    v_cvt_pk_bf16_f32 v148, v120, v121
    v_cvt_pk_bf16_f32 v149, v122, v123
    v_cvt_pk_bf16_f32 v150, v124, v125
    v_cvt_pk_bf16_f32 v151, v126, v127
    v_cvt_pk_bf16_f32 v152, v128, v129
    v_cvt_pk_bf16_f32 v153, v130, v131
    v_cvt_pk_bf16_f32 v154, v132, v133
    v_cvt_pk_bf16_f32 v155, v134, v135
    v_cvt_pk_bf16_f32 v156, v136, v137
    v_cvt_pk_bf16_f32 v157, v138, v139
    v_cvt_pk_bf16_f32 v158, v140, v141
    v_cvt_pk_bf16_f32 v159, v142, v143
    v_add_f32 v112, v112, v128
    v_add_f32 v113, v113, v129
    v_add_f32 v114, v114, v130
    v_add_f32 v115, v115, v131
    v_add_f32 v116, v116, v132
    v_add_f32 v117, v117, v133
    v_add_f32 v118, v118, v134
    v_add_f32 v119, v119, v135
    v_add_f32 v120, v120, v136
    v_add_f32 v121, v121, v137
    v_add_f32 v122, v122, v138
    v_add_f32 v123, v123, v139
    v_add_f32 v124, v124, v140
    v_add_f32 v125, v125, v141
    v_add_f32 v126, v126, v142
    v_add_f32 v127, v127, v143
    v_add_f32 v112, v112, v120
    v_add_f32 v113, v113, v121
    v_add_f32 v114, v114, v122
    v_add_f32 v115, v115, v123
    v_add_f32 v116, v116, v124
    v_add_f32 v117, v117, v125
    v_add_f32 v118, v118, v126
    v_add_f32 v119, v119, v127
    v_add_f32 v112, v112, v116
    v_add_f32 v113, v113, v117
    v_add_f32 v114, v114, v118
    v_add_f32 v115, v115, v119
    v_add_f32 v112, v112, v114
    v_add_f32 v113, v113, v115
    v_add_f32 v205, v205, v112
    v_add_f32 v205, v205, v113
    ds_read_b64_tr_b16 v[160:161], v200 offset:32768
    ds_read_b64_tr_b16 v[162:163], v200 offset:34816
    ds_read_b64_tr_b16 v[164:165], v201 offset:32768
    ds_read_b64_tr_b16 v[166:167], v201 offset:34816
    ds_read_b64_tr_b16 v[168:169], v202 offset:32768
    ds_read_b64_tr_b16 v[170:171], v202 offset:34816
    ds_read_b64_tr_b16 v[172:173], v203 offset:32768
    ds_read_b64_tr_b16 v[174:175], v203 offset:34816
    ds_read_b64_tr_b16 v[176:177], v200 offset:36864
    ds_read_b64_tr_b16 v[178:179], v200 offset:38912
    ds_read_b64_tr_b16 v[180:181], v201 offset:36864
    ds_read_b64_tr_b16 v[182:183], v201 offset:38912
    ds_read_b64_tr_b16 v[184:185], v202 offset:36864
    ds_read_b64_tr_b16 v[186:187], v202 offset:38912
    ds_read_b64_tr_b16 v[188:189], v203 offset:36864
    ds_read_b64_tr_b16 v[190:191], v203 offset:38912
    s_waitcnt lgkmcnt(14)
    v_mfma_f32_32x32x16_bf16 v[48:63], v[160:163], v[144:147], v[48:63]
    ds_read_b64_tr_b16 v[160:161], v200 offset:40960
    ds_read_b64_tr_b16 v[162:163], v200 offset:43008
    s_waitcnt lgkmcnt(14)
    v_mfma_f32_32x32x16_bf16 v[64:79], v[164:167], v[144:147], v[64:79]
    ds_read_b64_tr_b16 v[164:165], v201 offset:40960
    ds_read_b64_tr_b16 v[166:167], v201 offset:43008
    s_waitcnt lgkmcnt(14)
    v_mfma_f32_32x32x16_bf16 v[80:95], v[168:171], v[144:147], v[80:95]
    ds_read_b64_tr_b16 v[168:169], v202 offset:40960
    ds_read_b64_tr_b16 v[170:171], v202 offset:43008
    s_waitcnt lgkmcnt(14)
    v_mfma_f32_32x32x16_bf16 v[96:111], v[172:175], v[144:147], v[96:111]
    ds_read_b64_tr_b16 v[172:173], v203 offset:40960
    ds_read_b64_tr_b16 v[174:175], v203 offset:43008
    s_waitcnt lgkmcnt(14)
    v_mfma_f32_32x32x16_bf16 v[48:63], v[176:179], v[148:151], v[48:63]
    ds_read_b64_tr_b16 v[176:177], v200 offset:45056
    ds_read_b64_tr_b16 v[178:179], v200 offset:47104
    s_waitcnt lgkmcnt(14)
    v_mfma_f32_32x32x16_bf16 v[64:79], v[180:183], v[148:151], v[64:79]
    ds_read_b64_tr_b16 v[180:181], v201 offset:45056
    ds_read_b64_tr_b16 v[182:183], v201 offset:47104
    s_waitcnt lgkmcnt(14)
    v_mfma_f32_32x32x16_bf16 v[80:95], v[184:187], v[148:151], v[80:95]
    ds_read_b64_tr_b16 v[184:185], v202 offset:45056
    ds_read_b64_tr_b16 v[186:187], v202 offset:47104
    s_waitcnt lgkmcnt(14)
    v_mfma_f32_32x32x16_bf16 v[96:111], v[188:191], v[148:151], v[96:111]
    ds_read_b64_tr_b16 v[188:189], v203 offset:45056
    ds_read_b64_tr_b16 v[190:191], v203 offset:47104
    s_waitcnt lgkmcnt(14)
    v_mfma_f32_32x32x16_bf16 v[48:63], v[160:163], v[152:155], v[48:63]
    s_waitcnt lgkmcnt(12)
    v_mfma_f32_32x32x16_bf16 v[64:79], v[164:167], v[152:155], v[64:79]
    s_waitcnt lgkmcnt(10)
    v_mfma_f32_32x32x16_bf16 v[80:95], v[168:171], v[152:155], v[80:95]
    s_waitcnt lgkmcnt(8)
    v_mfma_f32_32x32x16_bf16 v[96:111], v[172:175], v[152:155], v[96:111]
    s_waitcnt lgkmcnt(6)
    v_mfma_f32_32x32x16_bf16 v[48:63], v[176:179], v[156:159], v[48:63]
    s_waitcnt lgkmcnt(4)
    v_mfma_f32_32x32x16_bf16 v[64:79], v[180:183], v[156:159], v[64:79]
    s_waitcnt lgkmcnt(2)
    v_mfma_f32_32x32x16_bf16 v[80:95], v[184:187], v[156:159], v[80:95]
    s_waitcnt lgkmcnt(0)
    v_mfma_f32_32x32x16_bf16 v[96:111], v[188:191], v[156:159], v[96:111]
    s_nop 11
.Lattn_kernel_g1s0:
    s_cmp_gt_u32 s35, s37
    s_cbranch_scc1 .Lattn_kernel_g1q0
    ds_read_b128 v[160:163], v192 offset:0
    ds_read_b128 v[164:167], v193 offset:0
    ds_read_b128 v[168:171], v194 offset:0
    ds_read_b128 v[172:175], v195 offset:0
    ds_read_b128 v[176:179], v196 offset:0
    ds_read_b128 v[180:183], v197 offset:0
    ds_read_b128 v[184:187], v198 offset:0
    ds_read_b128 v[188:191], v199 offset:0
    s_waitcnt lgkmcnt(7)
    v_mfma_f32_32x32x16_bf16 v[112:127], v[160:163], v[16:19], 0
    ds_read_b128 v[160:163], v192 offset:8192
    s_waitcnt lgkmcnt(7)
    v_mfma_f32_32x32x16_bf16 v[112:127], v[164:167], v[20:23], v[112:127]
    ds_read_b128 v[164:167], v193 offset:8192
    s_waitcnt lgkmcnt(7)
    v_mfma_f32_32x32x16_bf16 v[112:127], v[168:171], v[24:27], v[112:127]
    ds_read_b128 v[168:171], v194 offset:8192
    s_waitcnt lgkmcnt(7)
    v_mfma_f32_32x32x16_bf16 v[112:127], v[172:175], v[28:31], v[112:127]
    ds_read_b128 v[172:175], v195 offset:8192
    s_waitcnt lgkmcnt(7)
    v_mfma_f32_32x32x16_bf16 v[112:127], v[176:179], v[32:35], v[112:127]
    ds_read_b128 v[176:179], v196 offset:8192
    s_waitcnt lgkmcnt(7)
    v_mfma_f32_32x32x16_bf16 v[112:127], v[180:183], v[36:39], v[112:127]
    ds_read_b128 v[180:183], v197 offset:8192
    s_waitcnt lgkmcnt(7)
    v_mfma_f32_32x32x16_bf16 v[112:127], v[184:187], v[40:43], v[112:127]
    ds_read_b128 v[184:187], v198 offset:8192
    s_waitcnt lgkmcnt(7)
    v_mfma_f32_32x32x16_bf16 v[112:127], v[188:191], v[44:47], v[112:127]
    ds_read_b128 v[188:191], v199 offset:8192
    s_waitcnt lgkmcnt(7)
    v_mfma_f32_32x32x16_bf16 v[128:143], v[160:163], v[16:19], 0
    s_waitcnt lgkmcnt(6)
    v_mfma_f32_32x32x16_bf16 v[128:143], v[164:167], v[20:23], v[128:143]
    s_waitcnt lgkmcnt(5)
    v_mfma_f32_32x32x16_bf16 v[128:143], v[168:171], v[24:27], v[128:143]
    s_waitcnt lgkmcnt(4)
    v_mfma_f32_32x32x16_bf16 v[128:143], v[172:175], v[28:31], v[128:143]
    s_waitcnt lgkmcnt(3)
    v_mfma_f32_32x32x16_bf16 v[128:143], v[176:179], v[32:35], v[128:143]
    s_waitcnt lgkmcnt(2)
    v_mfma_f32_32x32x16_bf16 v[128:143], v[180:183], v[36:39], v[128:143]
    s_waitcnt lgkmcnt(1)
    v_mfma_f32_32x32x16_bf16 v[128:143], v[184:187], v[40:43], v[128:143]
    s_waitcnt lgkmcnt(0)
    v_mfma_f32_32x32x16_bf16 v[128:143], v[188:191], v[44:47], v[128:143]
    s_nop 11
.Lattn_kernel_g1q0:
    s_add_u32 s35, s35, 2
    s_add_u32 s47, s47, 1
    s_cmp_lt_u32 s47, s34
    s_cbranch_scc0 .Lattn_kernel_g1t0
    s_barrier
    s_sub_u32 s50, s35, 2
    s_cmp_eq_u32 s47, 0
    s_cbranch_scc1 .Lattn_kernel_g1s1
    s_cmp_gt_u32 s50, s37
    s_cbranch_scc1 .Lattn_kernel_g1s1
    s_lshl_b32 s40, s29, 1
    s_cmp_lt_u32 s50, s40
    s_cbranch_scc1 .Lattn_kernel_nomaskb1
    s_lshl_b32 s40, s50, 6
    v_lshlrev_b32 v206, 2, v4
    v_add_u32 v206, s40, v206
    v_sub_u32 v208, v5, v206
    v_mov_b32 v207, 0xff800000
    v_cmp_gt_i32 vcc, 0, v208
    s_nop 1
    v_cndmask_b32 v112, v112, v207, vcc
    v_cmp_gt_i32 vcc, 1, v208
    s_nop 1
    v_cndmask_b32 v113, v113, v207, vcc
    v_cmp_gt_i32 vcc, 2, v208
    s_nop 1
    v_cndmask_b32 v114, v114, v207, vcc
    v_cmp_gt_i32 vcc, 3, v208
    s_nop 1
    v_cndmask_b32 v115, v115, v207, vcc
    v_cmp_gt_i32 vcc, 8, v208
    s_nop 1
    v_cndmask_b32 v116, v116, v207, vcc
    v_cmp_gt_i32 vcc, 9, v208
    s_nop 1
    v_cndmask_b32 v117, v117, v207, vcc
    v_cmp_gt_i32 vcc, 10, v208
    s_nop 1
    v_cndmask_b32 v118, v118, v207, vcc
    v_cmp_gt_i32 vcc, 11, v208
    s_nop 1
    v_cndmask_b32 v119, v119, v207, vcc
    v_cmp_gt_i32 vcc, 16, v208
    s_nop 1
    v_cndmask_b32 v120, v120, v207, vcc
    v_cmp_gt_i32 vcc, 17, v208
    s_nop 1
    v_cndmask_b32 v121, v121, v207, vcc
    v_cmp_gt_i32 vcc, 18, v208
    s_nop 1
    v_cndmask_b32 v122, v122, v207, vcc
    v_cmp_gt_i32 vcc, 19, v208
    s_nop 1
    v_cndmask_b32 v123, v123, v207, vcc
    v_cmp_gt_i32 vcc, 24, v208
    s_nop 1
    v_cndmask_b32 v124, v124, v207, vcc
    v_cmp_gt_i32 vcc, 25, v208
    s_nop 1
    v_cndmask_b32 v125, v125, v207, vcc
    v_cmp_gt_i32 vcc, 26, v208
    s_nop 1
    v_cndmask_b32 v126, v126, v207, vcc
    v_cmp_gt_i32 vcc, 27, v208
    s_nop 1
    v_cndmask_b32 v127, v127, v207, vcc
    v_cmp_gt_i32 vcc, 32, v208
    s_nop 1
    v_cndmask_b32 v128, v128, v207, vcc
    v_cmp_gt_i32 vcc, 33, v208
    s_nop 1
    v_cndmask_b32 v129, v129, v207, vcc
    v_cmp_gt_i32 vcc, 34, v208
    s_nop 1
    v_cndmask_b32 v130, v130, v207, vcc
    v_cmp_gt_i32 vcc, 35, v208
    s_nop 1
    v_cndmask_b32 v131, v131, v207, vcc
    v_cmp_gt_i32 vcc, 40, v208
    s_nop 1
    v_cndmask_b32 v132, v132, v207, vcc
    v_cmp_gt_i32 vcc, 41, v208
    s_nop 1
    v_cndmask_b32 v133, v133, v207, vcc
    v_cmp_gt_i32 vcc, 42, v208
    s_nop 1
    v_cndmask_b32 v134, v134, v207, vcc
    v_cmp_gt_i32 vcc, 43, v208
    s_nop 1
    v_cndmask_b32 v135, v135, v207, vcc
    v_cmp_gt_i32 vcc, 48, v208
    s_nop 1
    v_cndmask_b32 v136, v136, v207, vcc
    v_cmp_gt_i32 vcc, 49, v208
    s_nop 1
    v_cndmask_b32 v137, v137, v207, vcc
    v_cmp_gt_i32 vcc, 50, v208
    s_nop 1
    v_cndmask_b32 v138, v138, v207, vcc
    v_cmp_gt_i32 vcc, 51, v208
    s_nop 1
    v_cndmask_b32 v139, v139, v207, vcc
    v_cmp_gt_i32 vcc, 56, v208
    s_nop 1
    v_cndmask_b32 v140, v140, v207, vcc
    v_cmp_gt_i32 vcc, 57, v208
    s_nop 1
    v_cndmask_b32 v141, v141, v207, vcc
    v_cmp_gt_i32 vcc, 58, v208
    s_nop 1
    v_cndmask_b32 v142, v142, v207, vcc
    v_cmp_gt_i32 vcc, 59, v208
    s_nop 1
    v_cndmask_b32 v143, v143, v207, vcc
    s_nop 4
.Lattn_kernel_nomaskb1:
    v_max3_f32 v206, v112, v113, v114
    v_max3_f32 v207, v115, v116, v117
    v_max3_f32 v206, v206, v118, v119
    v_max3_f32 v207, v207, v120, v121
    v_max3_f32 v206, v206, v122, v123
    v_max3_f32 v207, v207, v124, v125
    v_max3_f32 v206, v206, v126, v127
    v_max3_f32 v207, v207, v128, v129
    v_max3_f32 v206, v206, v130, v131
    v_max3_f32 v207, v207, v132, v133
    v_max3_f32 v206, v206, v134, v135
    v_max3_f32 v207, v207, v136, v137
    v_max3_f32 v206, v206, v138, v139
    v_max3_f32 v207, v207, v140, v141
    v_max3_f32 v206, v206, v142, v143
    v_max_f32 v206, v206, v207
    v_mov_b32 v207, v206
    s_nop 1
    v_permlane32_swap_b32 v206, v207
    v_max_f32 v206, v206, v207
    v_cmp_gt_f32 vcc, v206, v211
    s_nop 4
    s_cbranch_vccz .Lattn_kernel_norescb1
    v_max_f32 v209, v206, v204
    v_sub_f32 v210, v204, v209
    v_mul_f32 v210, s39, v210
    v_exp_f32 v210, v210
    v_mov_b32 v204, v209
    v_add_f32 v211, s42, v209
    v_mul_f32 v212, s39, v209
    v_sub_f32 v212, 0, v212
    v_mov_b32 v213, v212
    v_mul_f32 v205, v205, v210
    v_mul_f32 v48, v48, v210
    v_mul_f32 v49, v49, v210
    v_mul_f32 v50, v50, v210
    v_mul_f32 v51, v51, v210
    v_mul_f32 v52, v52, v210
    v_mul_f32 v53, v53, v210
    v_mul_f32 v54, v54, v210
    v_mul_f32 v55, v55, v210
    v_mul_f32 v56, v56, v210
    v_mul_f32 v57, v57, v210
    v_mul_f32 v58, v58, v210
    v_mul_f32 v59, v59, v210
    v_mul_f32 v60, v60, v210
    v_mul_f32 v61, v61, v210
    v_mul_f32 v62, v62, v210
    v_mul_f32 v63, v63, v210
    v_mul_f32 v64, v64, v210
    v_mul_f32 v65, v65, v210
    v_mul_f32 v66, v66, v210
    v_mul_f32 v67, v67, v210
    v_mul_f32 v68, v68, v210
    v_mul_f32 v69, v69, v210
    v_mul_f32 v70, v70, v210
    v_mul_f32 v71, v71, v210
    v_mul_f32 v72, v72, v210
    v_mul_f32 v73, v73, v210
    v_mul_f32 v74, v74, v210
    v_mul_f32 v75, v75, v210
    v_mul_f32 v76, v76, v210
    v_mul_f32 v77, v77, v210
    v_mul_f32 v78, v78, v210
    v_mul_f32 v79, v79, v210
    v_mul_f32 v80, v80, v210
    v_mul_f32 v81, v81, v210
    v_mul_f32 v82, v82, v210
    v_mul_f32 v83, v83, v210
    v_mul_f32 v84, v84, v210
    v_mul_f32 v85, v85, v210
    v_mul_f32 v86, v86, v210
    v_mul_f32 v87, v87, v210
    v_mul_f32 v88, v88, v210
    v_mul_f32 v89, v89, v210
    v_mul_f32 v90, v90, v210
    v_mul_f32 v91, v91, v210
    v_mul_f32 v92, v92, v210
    v_mul_f32 v93, v93, v210
    v_mul_f32 v94, v94, v210
    v_mul_f32 v95, v95, v210
    v_mul_f32 v96, v96, v210
    v_mul_f32 v97, v97, v210
    v_mul_f32 v98, v98, v210
    v_mul_f32 v99, v99, v210
    v_mul_f32 v100, v100, v210
    v_mul_f32 v101, v101, v210
    v_mul_f32 v102, v102, v210
    v_mul_f32 v103, v103, v210
    v_mul_f32 v104, v104, v210
    v_mul_f32 v105, v105, v210
    v_mul_f32 v106, v106, v210
    v_mul_f32 v107, v107, v210
    v_mul_f32 v108, v108, v210
    v_mul_f32 v109, v109, v210
    v_mul_f32 v110, v110, v210
    v_mul_f32 v111, v111, v210
    s_nop 4
.Lattn_kernel_norescb1:
    v_fma_f32 v112, v112, s39, v212
    v_fma_f32 v113, v113, s39, v212
    v_fma_f32 v114, v114, s39, v212
    v_fma_f32 v115, v115, s39, v212
    v_fma_f32 v116, v116, s39, v212
    v_fma_f32 v117, v117, s39, v212
    v_fma_f32 v118, v118, s39, v212
    v_fma_f32 v119, v119, s39, v212
    v_fma_f32 v120, v120, s39, v212
    v_fma_f32 v121, v121, s39, v212
    v_fma_f32 v122, v122, s39, v212
    v_fma_f32 v123, v123, s39, v212
    v_fma_f32 v124, v124, s39, v212
    v_fma_f32 v125, v125, s39, v212
    v_fma_f32 v126, v126, s39, v212
    v_fma_f32 v127, v127, s39, v212
    v_fma_f32 v128, v128, s39, v212
    v_fma_f32 v129, v129, s39, v212
    v_fma_f32 v130, v130, s39, v212
    v_fma_f32 v131, v131, s39, v212
    v_fma_f32 v132, v132, s39, v212
    v_fma_f32 v133, v133, s39, v212
    v_fma_f32 v134, v134, s39, v212
    v_fma_f32 v135, v135, s39, v212
    v_fma_f32 v136, v136, s39, v212
    v_fma_f32 v137, v137, s39, v212
    v_fma_f32 v138, v138, s39, v212
    v_fma_f32 v139, v139, s39, v212
    v_fma_f32 v140, v140, s39, v212
    v_fma_f32 v141, v141, s39, v212
    v_fma_f32 v142, v142, s39, v212
    v_fma_f32 v143, v143, s39, v212
    v_exp_f32 v112, v112
    v_exp_f32 v113, v113
    v_exp_f32 v114, v114
    v_exp_f32 v115, v115
    v_exp_f32 v116, v116
    v_exp_f32 v117, v117
    v_exp_f32 v118, v118
    v_exp_f32 v119, v119
    v_exp_f32 v120, v120
    v_exp_f32 v121, v121
    v_exp_f32 v122, v122
    v_exp_f32 v123, v123
    v_exp_f32 v124, v124
    v_exp_f32 v125, v125
    v_exp_f32 v126, v126
    v_exp_f32 v127, v127
    v_exp_f32 v128, v128
    v_exp_f32 v129, v129
    v_exp_f32 v130, v130
    v_exp_f32 v131, v131
    v_exp_f32 v132, v132
    v_exp_f32 v133, v133
    v_exp_f32 v134, v134
    v_exp_f32 v135, v135
    v_exp_f32 v136, v136
    v_exp_f32 v137, v137
    v_exp_f32 v138, v138
    v_exp_f32 v139, v139
    v_exp_f32 v140, v140
    v_exp_f32 v141, v141
    v_exp_f32 v142, v142
    v_exp_f32 v143, v143
    v_cvt_pk_bf16_f32 v144, v112, v113
    v_cvt_pk_bf16_f32 v145, v114, v115
    v_cvt_pk_bf16_f32 v146, v116, v117
    v_cvt_pk_bf16_f32 v147, v118, v119
    v_cvt_pk_bf16_f32 v148, v120, v121
    v_cvt_pk_bf16_f32 v149, v122, v123
    v_cvt_pk_bf16_f32 v150, v124, v125
    v_cvt_pk_bf16_f32 v151, v126, v127
    v_cvt_pk_bf16_f32 v152, v128, v129
    v_cvt_pk_bf16_f32 v153, v130, v131
    v_cvt_pk_bf16_f32 v154, v132, v133
    v_cvt_pk_bf16_f32 v155, v134, v135
    v_cvt_pk_bf16_f32 v156, v136, v137
    v_cvt_pk_bf16_f32 v157, v138, v139
    v_cvt_pk_bf16_f32 v158, v140, v141
    v_cvt_pk_bf16_f32 v159, v142, v143
    v_add_f32 v112, v112, v128
    v_add_f32 v113, v113, v129
    v_add_f32 v114, v114, v130
    v_add_f32 v115, v115, v131
    v_add_f32 v116, v116, v132
    v_add_f32 v117, v117, v133
    v_add_f32 v118, v118, v134
    v_add_f32 v119, v119, v135
    v_add_f32 v120, v120, v136
    v_add_f32 v121, v121, v137
    v_add_f32 v122, v122, v138
    v_add_f32 v123, v123, v139
    v_add_f32 v124, v124, v140
    v_add_f32 v125, v125, v141
    v_add_f32 v126, v126, v142
    v_add_f32 v127, v127, v143
    v_add_f32 v112, v112, v120
    v_add_f32 v113, v113, v121
    v_add_f32 v114, v114, v122
    v_add_f32 v115, v115, v123
    v_add_f32 v116, v116, v124
    v_add_f32 v117, v117, v125
    v_add_f32 v118, v118, v126
    v_add_f32 v119, v119, v127
    v_add_f32 v112, v112, v116
    v_add_f32 v113, v113, v117
    v_add_f32 v114, v114, v118
    v_add_f32 v115, v115, v119
    v_add_f32 v112, v112, v114
    v_add_f32 v113, v113, v115
    v_add_f32 v205, v205, v112
    v_add_f32 v205, v205, v113
    ds_read_b64_tr_b16 v[160:161], v200 offset:0
    ds_read_b64_tr_b16 v[162:163], v200 offset:2048
    ds_read_b64_tr_b16 v[164:165], v201 offset:0
    ds_read_b64_tr_b16 v[166:167], v201 offset:2048
    ds_read_b64_tr_b16 v[168:169], v202 offset:0
    ds_read_b64_tr_b16 v[170:171], v202 offset:2048
    ds_read_b64_tr_b16 v[172:173], v203 offset:0
    ds_read_b64_tr_b16 v[174:175], v203 offset:2048
    ds_read_b64_tr_b16 v[176:177], v200 offset:4096
    ds_read_b64_tr_b16 v[178:179], v200 offset:6144
    ds_read_b64_tr_b16 v[180:181], v201 offset:4096
    ds_read_b64_tr_b16 v[182:183], v201 offset:6144
    ds_read_b64_tr_b16 v[184:185], v202 offset:4096
    ds_read_b64_tr_b16 v[186:187], v202 offset:6144
    ds_read_b64_tr_b16 v[188:189], v203 offset:4096
    ds_read_b64_tr_b16 v[190:191], v203 offset:6144
    s_waitcnt lgkmcnt(14)
    v_mfma_f32_32x32x16_bf16 v[48:63], v[160:163], v[144:147], v[48:63]
    ds_read_b64_tr_b16 v[160:161], v200 offset:8192
    ds_read_b64_tr_b16 v[162:163], v200 offset:10240
    s_waitcnt lgkmcnt(14)
    v_mfma_f32_32x32x16_bf16 v[64:79], v[164:167], v[144:147], v[64:79]
    ds_read_b64_tr_b16 v[164:165], v201 offset:8192
    ds_read_b64_tr_b16 v[166:167], v201 offset:10240
    s_waitcnt lgkmcnt(14)
    v_mfma_f32_32x32x16_bf16 v[80:95], v[168:171], v[144:147], v[80:95]
    ds_read_b64_tr_b16 v[168:169], v202 offset:8192
    ds_read_b64_tr_b16 v[170:171], v202 offset:10240
    s_waitcnt lgkmcnt(14)
    v_mfma_f32_32x32x16_bf16 v[96:111], v[172:175], v[144:147], v[96:111]
    ds_read_b64_tr_b16 v[172:173], v203 offset:8192
    ds_read_b64_tr_b16 v[174:175], v203 offset:10240
    s_waitcnt lgkmcnt(14)
    v_mfma_f32_32x32x16_bf16 v[48:63], v[176:179], v[148:151], v[48:63]
    ds_read_b64_tr_b16 v[176:177], v200 offset:12288
    ds_read_b64_tr_b16 v[178:179], v200 offset:14336
    s_waitcnt lgkmcnt(14)
    v_mfma_f32_32x32x16_bf16 v[64:79], v[180:183], v[148:151], v[64:79]
    ds_read_b64_tr_b16 v[180:181], v201 offset:12288
    ds_read_b64_tr_b16 v[182:183], v201 offset:14336
    s_waitcnt lgkmcnt(14)
    v_mfma_f32_32x32x16_bf16 v[80:95], v[184:187], v[148:151], v[80:95]
    ds_read_b64_tr_b16 v[184:185], v202 offset:12288
    ds_read_b64_tr_b16 v[186:187], v202 offset:14336
    s_waitcnt lgkmcnt(14)
    v_mfma_f32_32x32x16_bf16 v[96:111], v[188:191], v[148:151], v[96:111]
    ds_read_b64_tr_b16 v[188:189], v203 offset:12288
    ds_read_b64_tr_b16 v[190:191], v203 offset:14336
    s_waitcnt lgkmcnt(14)
    v_mfma_f32_32x32x16_bf16 v[48:63], v[160:163], v[152:155], v[48:63]
    s_waitcnt lgkmcnt(12)
    v_mfma_f32_32x32x16_bf16 v[64:79], v[164:167], v[152:155], v[64:79]
    s_waitcnt lgkmcnt(10)
    v_mfma_f32_32x32x16_bf16 v[80:95], v[168:171], v[152:155], v[80:95]
    s_waitcnt lgkmcnt(8)
    v_mfma_f32_32x32x16_bf16 v[96:111], v[172:175], v[152:155], v[96:111]
    s_waitcnt lgkmcnt(6)
    v_mfma_f32_32x32x16_bf16 v[48:63], v[176:179], v[156:159], v[48:63]
    s_waitcnt lgkmcnt(4)
    v_mfma_f32_32x32x16_bf16 v[64:79], v[180:183], v[156:159], v[64:79]
    s_waitcnt lgkmcnt(2)
    v_mfma_f32_32x32x16_bf16 v[80:95], v[184:187], v[156:159], v[80:95]
    s_waitcnt lgkmcnt(0)
    v_mfma_f32_32x32x16_bf16 v[96:111], v[188:191], v[156:159], v[96:111]
    s_nop 11
.Lattn_kernel_g1s1:
    s_cmp_gt_u32 s35, s37
    s_cbranch_scc1 .Lattn_kernel_g1q1
    ds_read_b128 v[160:163], v192 offset:32768
    ds_read_b128 v[164:167], v193 offset:32768
    ds_read_b128 v[168:171], v194 offset:32768
    ds_read_b128 v[172:175], v195 offset:32768
    ds_read_b128 v[176:179], v196 offset:32768
    ds_read_b128 v[180:183], v197 offset:32768
    ds_read_b128 v[184:187], v198 offset:32768
    ds_read_b128 v[188:191], v199 offset:32768
    s_waitcnt lgkmcnt(7)
    v_mfma_f32_32x32x16_bf16 v[112:127], v[160:163], v[16:19], 0
    ds_read_b128 v[160:163], v192 offset:40960
    s_waitcnt lgkmcnt(7)
    v_mfma_f32_32x32x16_bf16 v[112:127], v[164:167], v[20:23], v[112:127]
    ds_read_b128 v[164:167], v193 offset:40960
    s_waitcnt lgkmcnt(7)
    v_mfma_f32_32x32x16_bf16 v[112:127], v[168:171], v[24:27], v[112:127]
    ds_read_b128 v[168:171], v194 offset:40960
    s_waitcnt lgkmcnt(7)
    v_mfma_f32_32x32x16_bf16 v[112:127], v[172:175], v[28:31], v[112:127]
    ds_read_b128 v[172:175], v195 offset:40960
    s_waitcnt lgkmcnt(7)
    v_mfma_f32_32x32x16_bf16 v[112:127], v[176:179], v[32:35], v[112:127]
    ds_read_b128 v[176:179], v196 offset:40960
    s_waitcnt lgkmcnt(7)
    v_mfma_f32_32x32x16_bf16 v[112:127], v[180:183], v[36:39], v[112:127]
    ds_read_b128 v[180:183], v197 offset:40960
    s_waitcnt lgkmcnt(7)
    v_mfma_f32_32x32x16_bf16 v[112:127], v[184:187], v[40:43], v[112:127]
    ds_read_b128 v[184:187], v198 offset:40960
    s_waitcnt lgkmcnt(7)
    v_mfma_f32_32x32x16_bf16 v[112:127], v[188:191], v[44:47], v[112:127]
    ds_read_b128 v[188:191], v199 offset:40960
    s_waitcnt lgkmcnt(7)
    v_mfma_f32_32x32x16_bf16 v[128:143], v[160:163], v[16:19], 0
    s_waitcnt lgkmcnt(6)
    v_mfma_f32_32x32x16_bf16 v[128:143], v[164:167], v[20:23], v[128:143]
    s_waitcnt lgkmcnt(5)
    v_mfma_f32_32x32x16_bf16 v[128:143], v[168:171], v[24:27], v[128:143]
    s_waitcnt lgkmcnt(4)
    v_mfma_f32_32x32x16_bf16 v[128:143], v[172:175], v[28:31], v[128:143]
    s_waitcnt lgkmcnt(3)
    v_mfma_f32_32x32x16_bf16 v[128:143], v[176:179], v[32:35], v[128:143]
    s_waitcnt lgkmcnt(2)
    v_mfma_f32_32x32x16_bf16 v[128:143], v[180:183], v[36:39], v[128:143]
    s_waitcnt lgkmcnt(1)
    v_mfma_f32_32x32x16_bf16 v[128:143], v[184:187], v[40:43], v[128:143]
    s_waitcnt lgkmcnt(0)
    v_mfma_f32_32x32x16_bf16 v[128:143], v[188:191], v[44:47], v[128:143]
    s_nop 11
.Lattn_kernel_g1q1:
    s_add_u32 s35, s35, 2
    s_add_u32 s47, s47, 1
    s_cmp_lt_u32 s47, s34
    s_cbranch_scc1 .Lattn_kernel_g1loop
.Lattn_kernel_g1t1:
    s_barrier
    s_sub_u32 s50, s35, 2
    s_cmp_gt_u32 s50, s37
    s_cbranch_scc1 .Lattn_kernel_done
    s_lshl_b32 s40, s29, 1
    s_cmp_lt_u32 s50, s40
    s_cbranch_scc1 .Lattn_kernel_nomaskt1
    s_lshl_b32 s40, s50, 6
    v_lshlrev_b32 v206, 2, v4
    v_add_u32 v206, s40, v206
    v_sub_u32 v208, v5, v206
    v_mov_b32 v207, 0xff800000
    v_cmp_gt_i32 vcc, 0, v208
    s_nop 1
    v_cndmask_b32 v112, v112, v207, vcc
    v_cmp_gt_i32 vcc, 1, v208
    s_nop 1
    v_cndmask_b32 v113, v113, v207, vcc
    v_cmp_gt_i32 vcc, 2, v208
    s_nop 1
    v_cndmask_b32 v114, v114, v207, vcc
    v_cmp_gt_i32 vcc, 3, v208
    s_nop 1
    v_cndmask_b32 v115, v115, v207, vcc
    v_cmp_gt_i32 vcc, 8, v208
    s_nop 1
    v_cndmask_b32 v116, v116, v207, vcc
    v_cmp_gt_i32 vcc, 9, v208
    s_nop 1
    v_cndmask_b32 v117, v117, v207, vcc
    v_cmp_gt_i32 vcc, 10, v208
    s_nop 1
    v_cndmask_b32 v118, v118, v207, vcc
    v_cmp_gt_i32 vcc, 11, v208
    s_nop 1
    v_cndmask_b32 v119, v119, v207, vcc
    v_cmp_gt_i32 vcc, 16, v208
    s_nop 1
    v_cndmask_b32 v120, v120, v207, vcc
    v_cmp_gt_i32 vcc, 17, v208
    s_nop 1
    v_cndmask_b32 v121, v121, v207, vcc
    v_cmp_gt_i32 vcc, 18, v208
    s_nop 1
    v_cndmask_b32 v122, v122, v207, vcc
    v_cmp_gt_i32 vcc, 19, v208
    s_nop 1
    v_cndmask_b32 v123, v123, v207, vcc
    v_cmp_gt_i32 vcc, 24, v208
    s_nop 1
    v_cndmask_b32 v124, v124, v207, vcc
    v_cmp_gt_i32 vcc, 25, v208
    s_nop 1
    v_cndmask_b32 v125, v125, v207, vcc
    v_cmp_gt_i32 vcc, 26, v208
    s_nop 1
    v_cndmask_b32 v126, v126, v207, vcc
    v_cmp_gt_i32 vcc, 27, v208
    s_nop 1
    v_cndmask_b32 v127, v127, v207, vcc
    v_cmp_gt_i32 vcc, 32, v208
    s_nop 1
    v_cndmask_b32 v128, v128, v207, vcc
    v_cmp_gt_i32 vcc, 33, v208
    s_nop 1
    v_cndmask_b32 v129, v129, v207, vcc
    v_cmp_gt_i32 vcc, 34, v208
    s_nop 1
    v_cndmask_b32 v130, v130, v207, vcc
    v_cmp_gt_i32 vcc, 35, v208
    s_nop 1
    v_cndmask_b32 v131, v131, v207, vcc
    v_cmp_gt_i32 vcc, 40, v208
    s_nop 1
    v_cndmask_b32 v132, v132, v207, vcc
    v_cmp_gt_i32 vcc, 41, v208
    s_nop 1
    v_cndmask_b32 v133, v133, v207, vcc
    v_cmp_gt_i32 vcc, 42, v208
    s_nop 1
    v_cndmask_b32 v134, v134, v207, vcc
    v_cmp_gt_i32 vcc, 43, v208
    s_nop 1
    v_cndmask_b32 v135, v135, v207, vcc
    v_cmp_gt_i32 vcc, 48, v208
    s_nop 1
    v_cndmask_b32 v136, v136, v207, vcc
    v_cmp_gt_i32 vcc, 49, v208
    s_nop 1
    v_cndmask_b32 v137, v137, v207, vcc
    v_cmp_gt_i32 vcc, 50, v208
    s_nop 1
    v_cndmask_b32 v138, v138, v207, vcc
    v_cmp_gt_i32 vcc, 51, v208
    s_nop 1
    v_cndmask_b32 v139, v139, v207, vcc
    v_cmp_gt_i32 vcc, 56, v208
    s_nop 1
    v_cndmask_b32 v140, v140, v207, vcc
    v_cmp_gt_i32 vcc, 57, v208
    s_nop 1
    v_cndmask_b32 v141, v141, v207, vcc
    v_cmp_gt_i32 vcc, 58, v208
    s_nop 1
    v_cndmask_b32 v142, v142, v207, vcc
    v_cmp_gt_i32 vcc, 59, v208
    s_nop 1
    v_cndmask_b32 v143, v143, v207, vcc
    s_nop 4
.Lattn_kernel_nomaskt1:
    v_max3_f32 v206, v112, v113, v114
    v_max3_f32 v207, v115, v116, v117
    v_max3_f32 v206, v206, v118, v119
    v_max3_f32 v207, v207, v120, v121
    v_max3_f32 v206, v206, v122, v123
    v_max3_f32 v207, v207, v124, v125
    v_max3_f32 v206, v206, v126, v127
    v_max3_f32 v207, v207, v128, v129
    v_max3_f32 v206, v206, v130, v131
    v_max3_f32 v207, v207, v132, v133
    v_max3_f32 v206, v206, v134, v135
    v_max3_f32 v207, v207, v136, v137
    v_max3_f32 v206, v206, v138, v139
    v_max3_f32 v207, v207, v140, v141
    v_max3_f32 v206, v206, v142, v143
    v_max_f32 v206, v206, v207
    v_mov_b32 v207, v206
    s_nop 1
    v_permlane32_swap_b32 v206, v207
    v_max_f32 v206, v206, v207
    v_cmp_gt_f32 vcc, v206, v211
    s_nop 4
    s_cbranch_vccz .Lattn_kernel_noresct1
    v_max_f32 v209, v206, v204
    v_sub_f32 v210, v204, v209
    v_mul_f32 v210, s39, v210
    v_exp_f32 v210, v210
    v_mov_b32 v204, v209
    v_add_f32 v211, s42, v209
    v_mul_f32 v212, s39, v209
    v_sub_f32 v212, 0, v212
    v_mov_b32 v213, v212
    v_mul_f32 v205, v205, v210
    v_mul_f32 v48, v48, v210
    v_mul_f32 v49, v49, v210
    v_mul_f32 v50, v50, v210
    v_mul_f32 v51, v51, v210
    v_mul_f32 v52, v52, v210
    v_mul_f32 v53, v53, v210
    v_mul_f32 v54, v54, v210
    v_mul_f32 v55, v55, v210
    v_mul_f32 v56, v56, v210
    v_mul_f32 v57, v57, v210
    v_mul_f32 v58, v58, v210
    v_mul_f32 v59, v59, v210
    v_mul_f32 v60, v60, v210
    v_mul_f32 v61, v61, v210
    v_mul_f32 v62, v62, v210
    v_mul_f32 v63, v63, v210
    v_mul_f32 v64, v64, v210
    v_mul_f32 v65, v65, v210
    v_mul_f32 v66, v66, v210
    v_mul_f32 v67, v67, v210
    v_mul_f32 v68, v68, v210
    v_mul_f32 v69, v69, v210
    v_mul_f32 v70, v70, v210
    v_mul_f32 v71, v71, v210
    v_mul_f32 v72, v72, v210
    v_mul_f32 v73, v73, v210
    v_mul_f32 v74, v74, v210
    v_mul_f32 v75, v75, v210
    v_mul_f32 v76, v76, v210
    v_mul_f32 v77, v77, v210
    v_mul_f32 v78, v78, v210
    v_mul_f32 v79, v79, v210
    v_mul_f32 v80, v80, v210
    v_mul_f32 v81, v81, v210
    v_mul_f32 v82, v82, v210
    v_mul_f32 v83, v83, v210
    v_mul_f32 v84, v84, v210
    v_mul_f32 v85, v85, v210
    v_mul_f32 v86, v86, v210
    v_mul_f32 v87, v87, v210
    v_mul_f32 v88, v88, v210
    v_mul_f32 v89, v89, v210
    v_mul_f32 v90, v90, v210
    v_mul_f32 v91, v91, v210
    v_mul_f32 v92, v92, v210
    v_mul_f32 v93, v93, v210
    v_mul_f32 v94, v94, v210
    v_mul_f32 v95, v95, v210
    v_mul_f32 v96, v96, v210
    v_mul_f32 v97, v97, v210
    v_mul_f32 v98, v98, v210
    v_mul_f32 v99, v99, v210
    v_mul_f32 v100, v100, v210
    v_mul_f32 v101, v101, v210
    v_mul_f32 v102, v102, v210
    v_mul_f32 v103, v103, v210
    v_mul_f32 v104, v104, v210
    v_mul_f32 v105, v105, v210
    v_mul_f32 v106, v106, v210
    v_mul_f32 v107, v107, v210
    v_mul_f32 v108, v108, v210
    v_mul_f32 v109, v109, v210
    v_mul_f32 v110, v110, v210
    v_mul_f32 v111, v111, v210
    s_nop 4
.Lattn_kernel_noresct1:
    v_fma_f32 v112, v112, s39, v212
    v_fma_f32 v113, v113, s39, v212
    v_fma_f32 v114, v114, s39, v212
    v_fma_f32 v115, v115, s39, v212
    v_fma_f32 v116, v116, s39, v212
    v_fma_f32 v117, v117, s39, v212
    v_fma_f32 v118, v118, s39, v212
    v_fma_f32 v119, v119, s39, v212
    v_fma_f32 v120, v120, s39, v212
    v_fma_f32 v121, v121, s39, v212
    v_fma_f32 v122, v122, s39, v212
    v_fma_f32 v123, v123, s39, v212
    v_fma_f32 v124, v124, s39, v212
    v_fma_f32 v125, v125, s39, v212
    v_fma_f32 v126, v126, s39, v212
    v_fma_f32 v127, v127, s39, v212
    v_fma_f32 v128, v128, s39, v212
    v_fma_f32 v129, v129, s39, v212
    v_fma_f32 v130, v130, s39, v212
    v_fma_f32 v131, v131, s39, v212
    v_fma_f32 v132, v132, s39, v212
    v_fma_f32 v133, v133, s39, v212
    v_fma_f32 v134, v134, s39, v212
    v_fma_f32 v135, v135, s39, v212
    v_fma_f32 v136, v136, s39, v212
    v_fma_f32 v137, v137, s39, v212
    v_fma_f32 v138, v138, s39, v212
    v_fma_f32 v139, v139, s39, v212
    v_fma_f32 v140, v140, s39, v212
    v_fma_f32 v141, v141, s39, v212
    v_fma_f32 v142, v142, s39, v212
    v_fma_f32 v143, v143, s39, v212
    v_exp_f32 v112, v112
    v_exp_f32 v113, v113
    v_exp_f32 v114, v114
    v_exp_f32 v115, v115
    v_exp_f32 v116, v116
    v_exp_f32 v117, v117
    v_exp_f32 v118, v118
    v_exp_f32 v119, v119
    v_exp_f32 v120, v120
    v_exp_f32 v121, v121
    v_exp_f32 v122, v122
    v_exp_f32 v123, v123
    v_exp_f32 v124, v124
    v_exp_f32 v125, v125
    v_exp_f32 v126, v126
    v_exp_f32 v127, v127
    v_exp_f32 v128, v128
    v_exp_f32 v129, v129
    v_exp_f32 v130, v130
    v_exp_f32 v131, v131
    v_exp_f32 v132, v132
    v_exp_f32 v133, v133
    v_exp_f32 v134, v134
    v_exp_f32 v135, v135
    v_exp_f32 v136, v136
    v_exp_f32 v137, v137
    v_exp_f32 v138, v138
    v_exp_f32 v139, v139
    v_exp_f32 v140, v140
    v_exp_f32 v141, v141
    v_exp_f32 v142, v142
    v_exp_f32 v143, v143
    v_cvt_pk_bf16_f32 v144, v112, v113
    v_cvt_pk_bf16_f32 v145, v114, v115
    v_cvt_pk_bf16_f32 v146, v116, v117
    v_cvt_pk_bf16_f32 v147, v118, v119
    v_cvt_pk_bf16_f32 v148, v120, v121
    v_cvt_pk_bf16_f32 v149, v122, v123
    v_cvt_pk_bf16_f32 v150, v124, v125
    v_cvt_pk_bf16_f32 v151, v126, v127
    v_cvt_pk_bf16_f32 v152, v128, v129
    v_cvt_pk_bf16_f32 v153, v130, v131
    v_cvt_pk_bf16_f32 v154, v132, v133
    v_cvt_pk_bf16_f32 v155, v134, v135
    v_cvt_pk_bf16_f32 v156, v136, v137
    v_cvt_pk_bf16_f32 v157, v138, v139
    v_cvt_pk_bf16_f32 v158, v140, v141
    v_cvt_pk_bf16_f32 v159, v142, v143
    v_add_f32 v112, v112, v128
    v_add_f32 v113, v113, v129
    v_add_f32 v114, v114, v130
    v_add_f32 v115, v115, v131
    v_add_f32 v116, v116, v132
    v_add_f32 v117, v117, v133
    v_add_f32 v118, v118, v134
    v_add_f32 v119, v119, v135
    v_add_f32 v120, v120, v136
    v_add_f32 v121, v121, v137
    v_add_f32 v122, v122, v138
    v_add_f32 v123, v123, v139
    v_add_f32 v124, v124, v140
    v_add_f32 v125, v125, v141
    v_add_f32 v126, v126, v142
    v_add_f32 v127, v127, v143
    v_add_f32 v112, v112, v120
    v_add_f32 v113, v113, v121
    v_add_f32 v114, v114, v122
    v_add_f32 v115, v115, v123
    v_add_f32 v116, v116, v124
    v_add_f32 v117, v117, v125
    v_add_f32 v118, v118, v126
    v_add_f32 v119, v119, v127
    v_add_f32 v112, v112, v116
    v_add_f32 v113, v113, v117
    v_add_f32 v114, v114, v118
    v_add_f32 v115, v115, v119
    v_add_f32 v112, v112, v114
    v_add_f32 v113, v113, v115
    v_add_f32 v205, v205, v112
    v_add_f32 v205, v205, v113
    ds_read_b64_tr_b16 v[160:161], v200 offset:32768
    ds_read_b64_tr_b16 v[162:163], v200 offset:34816
    ds_read_b64_tr_b16 v[164:165], v201 offset:32768
    ds_read_b64_tr_b16 v[166:167], v201 offset:34816
    ds_read_b64_tr_b16 v[168:169], v202 offset:32768
    ds_read_b64_tr_b16 v[170:171], v202 offset:34816
    ds_read_b64_tr_b16 v[172:173], v203 offset:32768
    ds_read_b64_tr_b16 v[174:175], v203 offset:34816
    ds_read_b64_tr_b16 v[176:177], v200 offset:36864
    ds_read_b64_tr_b16 v[178:179], v200 offset:38912
    ds_read_b64_tr_b16 v[180:181], v201 offset:36864
    ds_read_b64_tr_b16 v[182:183], v201 offset:38912
    ds_read_b64_tr_b16 v[184:185], v202 offset:36864
    ds_read_b64_tr_b16 v[186:187], v202 offset:38912
    ds_read_b64_tr_b16 v[188:189], v203 offset:36864
    ds_read_b64_tr_b16 v[190:191], v203 offset:38912
    s_waitcnt lgkmcnt(14)
    v_mfma_f32_32x32x16_bf16 v[48:63], v[160:163], v[144:147], v[48:63]
    ds_read_b64_tr_b16 v[160:161], v200 offset:40960
    ds_read_b64_tr_b16 v[162:163], v200 offset:43008
    s_waitcnt lgkmcnt(14)
    v_mfma_f32_32x32x16_bf16 v[64:79], v[164:167], v[144:147], v[64:79]
    ds_read_b64_tr_b16 v[164:165], v201 offset:40960
    ds_read_b64_tr_b16 v[166:167], v201 offset:43008
    s_waitcnt lgkmcnt(14)
    v_mfma_f32_32x32x16_bf16 v[80:95], v[168:171], v[144:147], v[80:95]
    ds_read_b64_tr_b16 v[168:169], v202 offset:40960
    ds_read_b64_tr_b16 v[170:171], v202 offset:43008
    s_waitcnt lgkmcnt(14)
    v_mfma_f32_32x32x16_bf16 v[96:111], v[172:175], v[144:147], v[96:111]
    ds_read_b64_tr_b16 v[172:173], v203 offset:40960
    ds_read_b64_tr_b16 v[174:175], v203 offset:43008
    s_waitcnt lgkmcnt(14)
    v_mfma_f32_32x32x16_bf16 v[48:63], v[176:179], v[148:151], v[48:63]
    ds_read_b64_tr_b16 v[176:177], v200 offset:45056
    ds_read_b64_tr_b16 v[178:179], v200 offset:47104
    s_waitcnt lgkmcnt(14)
    v_mfma_f32_32x32x16_bf16 v[64:79], v[180:183], v[148:151], v[64:79]
    ds_read_b64_tr_b16 v[180:181], v201 offset:45056
    ds_read_b64_tr_b16 v[182:183], v201 offset:47104
    s_waitcnt lgkmcnt(14)
    v_mfma_f32_32x32x16_bf16 v[80:95], v[184:187], v[148:151], v[80:95]
    ds_read_b64_tr_b16 v[184:185], v202 offset:45056
    ds_read_b64_tr_b16 v[186:187], v202 offset:47104
    s_waitcnt lgkmcnt(14)
    v_mfma_f32_32x32x16_bf16 v[96:111], v[188:191], v[148:151], v[96:111]
    ds_read_b64_tr_b16 v[188:189], v203 offset:45056
    ds_read_b64_tr_b16 v[190:191], v203 offset:47104
    s_waitcnt lgkmcnt(14)
    v_mfma_f32_32x32x16_bf16 v[48:63], v[160:163], v[152:155], v[48:63]
    s_waitcnt lgkmcnt(12)
    v_mfma_f32_32x32x16_bf16 v[64:79], v[164:167], v[152:155], v[64:79]
    s_waitcnt lgkmcnt(10)
    v_mfma_f32_32x32x16_bf16 v[80:95], v[168:171], v[152:155], v[80:95]
    s_waitcnt lgkmcnt(8)
    v_mfma_f32_32x32x16_bf16 v[96:111], v[172:175], v[152:155], v[96:111]
    s_waitcnt lgkmcnt(6)
    v_mfma_f32_32x32x16_bf16 v[48:63], v[176:179], v[156:159], v[48:63]
    s_waitcnt lgkmcnt(4)
    v_mfma_f32_32x32x16_bf16 v[64:79], v[180:183], v[156:159], v[64:79]
    s_waitcnt lgkmcnt(2)
    v_mfma_f32_32x32x16_bf16 v[80:95], v[184:187], v[156:159], v[80:95]
    s_waitcnt lgkmcnt(0)
    v_mfma_f32_32x32x16_bf16 v[96:111], v[188:191], v[156:159], v[96:111]
    s_nop 11
    s_branch .Lattn_kernel_done
.Lattn_kernel_g1t0:
    s_barrier
    s_sub_u32 s50, s35, 2
    s_cmp_gt_u32 s50, s37
    s_cbranch_scc1 .Lattn_kernel_done
    s_lshl_b32 s40, s29, 1
    s_cmp_lt_u32 s50, s40
    s_cbranch_scc1 .Lattn_kernel_nomaskt0
    s_lshl_b32 s40, s50, 6
    v_lshlrev_b32 v206, 2, v4
    v_add_u32 v206, s40, v206
    v_sub_u32 v208, v5, v206
    v_mov_b32 v207, 0xff800000
    v_cmp_gt_i32 vcc, 0, v208
    s_nop 1
    v_cndmask_b32 v112, v112, v207, vcc
    v_cmp_gt_i32 vcc, 1, v208
    s_nop 1
    v_cndmask_b32 v113, v113, v207, vcc
    v_cmp_gt_i32 vcc, 2, v208
    s_nop 1
    v_cndmask_b32 v114, v114, v207, vcc
    v_cmp_gt_i32 vcc, 3, v208
    s_nop 1
    v_cndmask_b32 v115, v115, v207, vcc
    v_cmp_gt_i32 vcc, 8, v208
    s_nop 1
    v_cndmask_b32 v116, v116, v207, vcc
    v_cmp_gt_i32 vcc, 9, v208
    s_nop 1
    v_cndmask_b32 v117, v117, v207, vcc
    v_cmp_gt_i32 vcc, 10, v208
    s_nop 1
    v_cndmask_b32 v118, v118, v207, vcc
    v_cmp_gt_i32 vcc, 11, v208
    s_nop 1
    v_cndmask_b32 v119, v119, v207, vcc
    v_cmp_gt_i32 vcc, 16, v208
    s_nop 1
    v_cndmask_b32 v120, v120, v207, vcc
    v_cmp_gt_i32 vcc, 17, v208
    s_nop 1
    v_cndmask_b32 v121, v121, v207, vcc
    v_cmp_gt_i32 vcc, 18, v208
    s_nop 1
    v_cndmask_b32 v122, v122, v207, vcc
    v_cmp_gt_i32 vcc, 19, v208
    s_nop 1
    v_cndmask_b32 v123, v123, v207, vcc
    v_cmp_gt_i32 vcc, 24, v208
    s_nop 1
    v_cndmask_b32 v124, v124, v207, vcc
    v_cmp_gt_i32 vcc, 25, v208
    s_nop 1
    v_cndmask_b32 v125, v125, v207, vcc
    v_cmp_gt_i32 vcc, 26, v208
    s_nop 1
    v_cndmask_b32 v126, v126, v207, vcc
    v_cmp_gt_i32 vcc, 27, v208
    s_nop 1
    v_cndmask_b32 v127, v127, v207, vcc
    v_cmp_gt_i32 vcc, 32, v208
    s_nop 1
    v_cndmask_b32 v128, v128, v207, vcc
    v_cmp_gt_i32 vcc, 33, v208
    s_nop 1
    v_cndmask_b32 v129, v129, v207, vcc
    v_cmp_gt_i32 vcc, 34, v208
    s_nop 1
    v_cndmask_b32 v130, v130, v207, vcc
    v_cmp_gt_i32 vcc, 35, v208
    s_nop 1
    v_cndmask_b32 v131, v131, v207, vcc
    v_cmp_gt_i32 vcc, 40, v208
    s_nop 1
    v_cndmask_b32 v132, v132, v207, vcc
    v_cmp_gt_i32 vcc, 41, v208
    s_nop 1
    v_cndmask_b32 v133, v133, v207, vcc
    v_cmp_gt_i32 vcc, 42, v208
    s_nop 1
    v_cndmask_b32 v134, v134, v207, vcc
    v_cmp_gt_i32 vcc, 43, v208
    s_nop 1
    v_cndmask_b32 v135, v135, v207, vcc
    v_cmp_gt_i32 vcc, 48, v208
    s_nop 1
    v_cndmask_b32 v136, v136, v207, vcc
    v_cmp_gt_i32 vcc, 49, v208
    s_nop 1
    v_cndmask_b32 v137, v137, v207, vcc
    v_cmp_gt_i32 vcc, 50, v208
    s_nop 1
    v_cndmask_b32 v138, v138, v207, vcc
    v_cmp_gt_i32 vcc, 51, v208
    s_nop 1
    v_cndmask_b32 v139, v139, v207, vcc
    v_cmp_gt_i32 vcc, 56, v208
    s_nop 1
    v_cndmask_b32 v140, v140, v207, vcc
    v_cmp_gt_i32 vcc, 57, v208
    s_nop 1
    v_cndmask_b32 v141, v141, v207, vcc
    v_cmp_gt_i32 vcc, 58, v208
    s_nop 1
    v_cndmask_b32 v142, v142, v207, vcc
    v_cmp_gt_i32 vcc, 59, v208
    s_nop 1
    v_cndmask_b32 v143, v143, v207, vcc
    s_nop 4
.Lattn_kernel_nomaskt0:
    v_max3_f32 v206, v112, v113, v114
    v_max3_f32 v207, v115, v116, v117
    v_max3_f32 v206, v206, v118, v119
    v_max3_f32 v207, v207, v120, v121
    v_max3_f32 v206, v206, v122, v123
    v_max3_f32 v207, v207, v124, v125
    v_max3_f32 v206, v206, v126, v127
    v_max3_f32 v207, v207, v128, v129
    v_max3_f32 v206, v206, v130, v131
    v_max3_f32 v207, v207, v132, v133
    v_max3_f32 v206, v206, v134, v135
    v_max3_f32 v207, v207, v136, v137
    v_max3_f32 v206, v206, v138, v139
    v_max3_f32 v207, v207, v140, v141
    v_max3_f32 v206, v206, v142, v143
    v_max_f32 v206, v206, v207
    v_mov_b32 v207, v206
    s_nop 1
    v_permlane32_swap_b32 v206, v207
    v_max_f32 v206, v206, v207
    v_cmp_gt_f32 vcc, v206, v211
    s_nop 4
    s_cbranch_vccz .Lattn_kernel_noresct0
    v_max_f32 v209, v206, v204
    v_sub_f32 v210, v204, v209
    v_mul_f32 v210, s39, v210
    v_exp_f32 v210, v210
    v_mov_b32 v204, v209
    v_add_f32 v211, s42, v209
    v_mul_f32 v212, s39, v209
    v_sub_f32 v212, 0, v212
    v_mov_b32 v213, v212
    v_mul_f32 v205, v205, v210
    v_mul_f32 v48, v48, v210
    v_mul_f32 v49, v49, v210
    v_mul_f32 v50, v50, v210
    v_mul_f32 v51, v51, v210
    v_mul_f32 v52, v52, v210
    v_mul_f32 v53, v53, v210
    v_mul_f32 v54, v54, v210
    v_mul_f32 v55, v55, v210
    v_mul_f32 v56, v56, v210
    v_mul_f32 v57, v57, v210
    v_mul_f32 v58, v58, v210
    v_mul_f32 v59, v59, v210
    v_mul_f32 v60, v60, v210
    v_mul_f32 v61, v61, v210
    v_mul_f32 v62, v62, v210
    v_mul_f32 v63, v63, v210
    v_mul_f32 v64, v64, v210
    v_mul_f32 v65, v65, v210
    v_mul_f32 v66, v66, v210
    v_mul_f32 v67, v67, v210
    v_mul_f32 v68, v68, v210
    v_mul_f32 v69, v69, v210
    v_mul_f32 v70, v70, v210
    v_mul_f32 v71, v71, v210
    v_mul_f32 v72, v72, v210
    v_mul_f32 v73, v73, v210
    v_mul_f32 v74, v74, v210
    v_mul_f32 v75, v75, v210
    v_mul_f32 v76, v76, v210
    v_mul_f32 v77, v77, v210
    v_mul_f32 v78, v78, v210
    v_mul_f32 v79, v79, v210
    v_mul_f32 v80, v80, v210
    v_mul_f32 v81, v81, v210
    v_mul_f32 v82, v82, v210
    v_mul_f32 v83, v83, v210
    v_mul_f32 v84, v84, v210
    v_mul_f32 v85, v85, v210
    v_mul_f32 v86, v86, v210
    v_mul_f32 v87, v87, v210
    v_mul_f32 v88, v88, v210
    v_mul_f32 v89, v89, v210
    v_mul_f32 v90, v90, v210
    v_mul_f32 v91, v91, v210
    v_mul_f32 v92, v92, v210
    v_mul_f32 v93, v93, v210
    v_mul_f32 v94, v94, v210
    v_mul_f32 v95, v95, v210
    v_mul_f32 v96, v96, v210
    v_mul_f32 v97, v97, v210
    v_mul_f32 v98, v98, v210
    v_mul_f32 v99, v99, v210
    v_mul_f32 v100, v100, v210
    v_mul_f32 v101, v101, v210
    v_mul_f32 v102, v102, v210
    v_mul_f32 v103, v103, v210
    v_mul_f32 v104, v104, v210
    v_mul_f32 v105, v105, v210
    v_mul_f32 v106, v106, v210
    v_mul_f32 v107, v107, v210
    v_mul_f32 v108, v108, v210
    v_mul_f32 v109, v109, v210
    v_mul_f32 v110, v110, v210
    v_mul_f32 v111, v111, v210
    s_nop 4
.Lattn_kernel_noresct0:
    v_fma_f32 v112, v112, s39, v212
    v_fma_f32 v113, v113, s39, v212
    v_fma_f32 v114, v114, s39, v212
    v_fma_f32 v115, v115, s39, v212
    v_fma_f32 v116, v116, s39, v212
    v_fma_f32 v117, v117, s39, v212
    v_fma_f32 v118, v118, s39, v212
    v_fma_f32 v119, v119, s39, v212
    v_fma_f32 v120, v120, s39, v212
    v_fma_f32 v121, v121, s39, v212
    v_fma_f32 v122, v122, s39, v212
    v_fma_f32 v123, v123, s39, v212
    v_fma_f32 v124, v124, s39, v212
    v_fma_f32 v125, v125, s39, v212
    v_fma_f32 v126, v126, s39, v212
    v_fma_f32 v127, v127, s39, v212
    v_fma_f32 v128, v128, s39, v212
    v_fma_f32 v129, v129, s39, v212
    v_fma_f32 v130, v130, s39, v212
    v_fma_f32 v131, v131, s39, v212
    v_fma_f32 v132, v132, s39, v212
    v_fma_f32 v133, v133, s39, v212
    v_fma_f32 v134, v134, s39, v212
    v_fma_f32 v135, v135, s39, v212
    v_fma_f32 v136, v136, s39, v212
    v_fma_f32 v137, v137, s39, v212
    v_fma_f32 v138, v138, s39, v212
    v_fma_f32 v139, v139, s39, v212
    v_fma_f32 v140, v140, s39, v212
    v_fma_f32 v141, v141, s39, v212
    v_fma_f32 v142, v142, s39, v212
    v_fma_f32 v143, v143, s39, v212
    v_exp_f32 v112, v112
    v_exp_f32 v113, v113
    v_exp_f32 v114, v114
    v_exp_f32 v115, v115
    v_exp_f32 v116, v116
    v_exp_f32 v117, v117
    v_exp_f32 v118, v118
    v_exp_f32 v119, v119
    v_exp_f32 v120, v120
    v_exp_f32 v121, v121
    v_exp_f32 v122, v122
    v_exp_f32 v123, v123
    v_exp_f32 v124, v124
    v_exp_f32 v125, v125
    v_exp_f32 v126, v126
    v_exp_f32 v127, v127
    v_exp_f32 v128, v128
    v_exp_f32 v129, v129
    v_exp_f32 v130, v130
    v_exp_f32 v131, v131
    v_exp_f32 v132, v132
    v_exp_f32 v133, v133
    v_exp_f32 v134, v134
    v_exp_f32 v135, v135
    v_exp_f32 v136, v136
    v_exp_f32 v137, v137
    v_exp_f32 v138, v138
    v_exp_f32 v139, v139
    v_exp_f32 v140, v140
    v_exp_f32 v141, v141
    v_exp_f32 v142, v142
    v_exp_f32 v143, v143
    v_cvt_pk_bf16_f32 v144, v112, v113
    v_cvt_pk_bf16_f32 v145, v114, v115
    v_cvt_pk_bf16_f32 v146, v116, v117
    v_cvt_pk_bf16_f32 v147, v118, v119
    v_cvt_pk_bf16_f32 v148, v120, v121
    v_cvt_pk_bf16_f32 v149, v122, v123
    v_cvt_pk_bf16_f32 v150, v124, v125
    v_cvt_pk_bf16_f32 v151, v126, v127
    v_cvt_pk_bf16_f32 v152, v128, v129
    v_cvt_pk_bf16_f32 v153, v130, v131
    v_cvt_pk_bf16_f32 v154, v132, v133
    v_cvt_pk_bf16_f32 v155, v134, v135
    v_cvt_pk_bf16_f32 v156, v136, v137
    v_cvt_pk_bf16_f32 v157, v138, v139
    v_cvt_pk_bf16_f32 v158, v140, v141
    v_cvt_pk_bf16_f32 v159, v142, v143
    v_add_f32 v112, v112, v128
    v_add_f32 v113, v113, v129
    v_add_f32 v114, v114, v130
    v_add_f32 v115, v115, v131
    v_add_f32 v116, v116, v132
    v_add_f32 v117, v117, v133
    v_add_f32 v118, v118, v134
    v_add_f32 v119, v119, v135
    v_add_f32 v120, v120, v136
    v_add_f32 v121, v121, v137
    v_add_f32 v122, v122, v138
    v_add_f32 v123, v123, v139
    v_add_f32 v124, v124, v140
    v_add_f32 v125, v125, v141
    v_add_f32 v126, v126, v142
    v_add_f32 v127, v127, v143
    v_add_f32 v112, v112, v120
    v_add_f32 v113, v113, v121
    v_add_f32 v114, v114, v122
    v_add_f32 v115, v115, v123
    v_add_f32 v116, v116, v124
    v_add_f32 v117, v117, v125
    v_add_f32 v118, v118, v126
    v_add_f32 v119, v119, v127
    v_add_f32 v112, v112, v116
    v_add_f32 v113, v113, v117
    v_add_f32 v114, v114, v118
    v_add_f32 v115, v115, v119
    v_add_f32 v112, v112, v114
    v_add_f32 v113, v113, v115
    v_add_f32 v205, v205, v112
    v_add_f32 v205, v205, v113
    ds_read_b64_tr_b16 v[160:161], v200 offset:0
    ds_read_b64_tr_b16 v[162:163], v200 offset:2048
    ds_read_b64_tr_b16 v[164:165], v201 offset:0
    ds_read_b64_tr_b16 v[166:167], v201 offset:2048
    ds_read_b64_tr_b16 v[168:169], v202 offset:0
    ds_read_b64_tr_b16 v[170:171], v202 offset:2048
    ds_read_b64_tr_b16 v[172:173], v203 offset:0
    ds_read_b64_tr_b16 v[174:175], v203 offset:2048
    ds_read_b64_tr_b16 v[176:177], v200 offset:4096
    ds_read_b64_tr_b16 v[178:179], v200 offset:6144
    ds_read_b64_tr_b16 v[180:181], v201 offset:4096
    ds_read_b64_tr_b16 v[182:183], v201 offset:6144
    ds_read_b64_tr_b16 v[184:185], v202 offset:4096
    ds_read_b64_tr_b16 v[186:187], v202 offset:6144
    ds_read_b64_tr_b16 v[188:189], v203 offset:4096
    ds_read_b64_tr_b16 v[190:191], v203 offset:6144
    s_waitcnt lgkmcnt(14)
    v_mfma_f32_32x32x16_bf16 v[48:63], v[160:163], v[144:147], v[48:63]
    ds_read_b64_tr_b16 v[160:161], v200 offset:8192
    ds_read_b64_tr_b16 v[162:163], v200 offset:10240
    s_waitcnt lgkmcnt(14)
    v_mfma_f32_32x32x16_bf16 v[64:79], v[164:167], v[144:147], v[64:79]
    ds_read_b64_tr_b16 v[164:165], v201 offset:8192
    ds_read_b64_tr_b16 v[166:167], v201 offset:10240
    s_waitcnt lgkmcnt(14)
    v_mfma_f32_32x32x16_bf16 v[80:95], v[168:171], v[144:147], v[80:95]
    ds_read_b64_tr_b16 v[168:169], v202 offset:8192
    ds_read_b64_tr_b16 v[170:171], v202 offset:10240
    s_waitcnt lgkmcnt(14)
    v_mfma_f32_32x32x16_bf16 v[96:111], v[172:175], v[144:147], v[96:111]
    ds_read_b64_tr_b16 v[172:173], v203 offset:8192
    ds_read_b64_tr_b16 v[174:175], v203 offset:10240
    s_waitcnt lgkmcnt(14)
    v_mfma_f32_32x32x16_bf16 v[48:63], v[176:179], v[148:151], v[48:63]
    ds_read_b64_tr_b16 v[176:177], v200 offset:12288
    ds_read_b64_tr_b16 v[178:179], v200 offset:14336
    s_waitcnt lgkmcnt(14)
    v_mfma_f32_32x32x16_bf16 v[64:79], v[180:183], v[148:151], v[64:79]
    ds_read_b64_tr_b16 v[180:181], v201 offset:12288
    ds_read_b64_tr_b16 v[182:183], v201 offset:14336
    s_waitcnt lgkmcnt(14)
    v_mfma_f32_32x32x16_bf16 v[80:95], v[184:187], v[148:151], v[80:95]
    ds_read_b64_tr_b16 v[184:185], v202 offset:12288
    ds_read_b64_tr_b16 v[186:187], v202 offset:14336
    s_waitcnt lgkmcnt(14)
    v_mfma_f32_32x32x16_bf16 v[96:111], v[188:191], v[148:151], v[96:111]
    ds_read_b64_tr_b16 v[188:189], v203 offset:12288
    ds_read_b64_tr_b16 v[190:191], v203 offset:14336
    s_waitcnt lgkmcnt(14)
    v_mfma_f32_32x32x16_bf16 v[48:63], v[160:163], v[152:155], v[48:63]
    s_waitcnt lgkmcnt(12)
    v_mfma_f32_32x32x16_bf16 v[64:79], v[164:167], v[152:155], v[64:79]
    s_waitcnt lgkmcnt(10)
    v_mfma_f32_32x32x16_bf16 v[80:95], v[168:171], v[152:155], v[80:95]
    s_waitcnt lgkmcnt(8)
    v_mfma_f32_32x32x16_bf16 v[96:111], v[172:175], v[152:155], v[96:111]
    s_waitcnt lgkmcnt(6)
    v_mfma_f32_32x32x16_bf16 v[48:63], v[176:179], v[156:159], v[48:63]
    s_waitcnt lgkmcnt(4)
    v_mfma_f32_32x32x16_bf16 v[64:79], v[180:183], v[156:159], v[64:79]
    s_waitcnt lgkmcnt(2)
    v_mfma_f32_32x32x16_bf16 v[80:95], v[184:187], v[156:159], v[80:95]
    s_waitcnt lgkmcnt(0)
    v_mfma_f32_32x32x16_bf16 v[96:111], v[188:191], v[156:159], v[96:111]
    s_nop 11
    s_branch .Lattn_kernel_done
.Lattn_kernel_done:
    s_waitcnt vmcnt(0)
    s_barrier
    s_mul_i32 s40, s43, 36864
    v_add_u32 v6, s40, v216
    s_sub_u32 s40, 36864, s40
    v_add_u32 v7, s40, v216
    s_cmp_eq_u32 s43, 0
    s_nop 3
    s_cbranch_scc0 .Lattn_kernel_w1
    ds_write_b128 v6, v[80:83] offset:0
    ds_write_b128 v6, v[84:87] offset:1024
    ds_write_b128 v6, v[88:91] offset:2048
    ds_write_b128 v6, v[92:95] offset:3072
    ds_write_b128 v6, v[96:99] offset:4096
    ds_write_b128 v6, v[100:103] offset:5120
    ds_write_b128 v6, v[104:107] offset:6144
    ds_write_b128 v6, v[108:111] offset:7168
    s_branch .Lattn_kernel_w2
.Lattn_kernel_w1:
    ds_write_b128 v6, v[48:51] offset:0
    ds_write_b128 v6, v[52:55] offset:1024
    ds_write_b128 v6, v[56:59] offset:2048
    ds_write_b128 v6, v[60:63] offset:3072
    ds_write_b128 v6, v[64:67] offset:4096
    ds_write_b128 v6, v[68:71] offset:5120
    ds_write_b128 v6, v[72:75] offset:6144
    ds_write_b128 v6, v[76:79] offset:7168
    v_mov_b32 v48, v80
    v_mov_b32 v49, v81
    v_mov_b32 v50, v82
    v_mov_b32 v51, v83
    v_mov_b32 v52, v84
    v_mov_b32 v53, v85
    v_mov_b32 v54, v86
    v_mov_b32 v55, v87
    v_mov_b32 v56, v88
    v_mov_b32 v57, v89
    v_mov_b32 v58, v90
    v_mov_b32 v59, v91
    v_mov_b32 v60, v92
    v_mov_b32 v61, v93
    v_mov_b32 v62, v94
    v_mov_b32 v63, v95
    v_mov_b32 v64, v96
    v_mov_b32 v65, v97
    v_mov_b32 v66, v98
    v_mov_b32 v67, v99
    v_mov_b32 v68, v100
    v_mov_b32 v69, v101
    v_mov_b32 v70, v102
    v_mov_b32 v71, v103
    v_mov_b32 v72, v104
    v_mov_b32 v73, v105
    v_mov_b32 v74, v106
    v_mov_b32 v75, v107
    v_mov_b32 v76, v108
    v_mov_b32 v77, v109
    v_mov_b32 v78, v110
    v_mov_b32 v79, v111
    s_nop 4
.Lattn_kernel_w2:
    ds_write_b64 v6, v[204:205] offset:8192
    s_waitcnt lgkmcnt(0)
    s_barrier
    ds_read_b64 v[206:207], v7 offset:8192
    ds_read_b128 v[112:115], v7 offset:0
    ds_read_b128 v[116:119], v7 offset:1024
    ds_read_b128 v[120:123], v7 offset:2048
    ds_read_b128 v[124:127], v7 offset:3072
    ds_read_b128 v[128:131], v7 offset:4096
    ds_read_b128 v[132:135], v7 offset:5120
    ds_read_b128 v[136:139], v7 offset:6144
    ds_read_b128 v[140:143], v7 offset:7168
    s_waitcnt lgkmcnt(8)
    v_max_f32 v209, v204, v206
    v_sub_f32 v210, v204, v209
    v_mul_f32 v210, s39, v210
    v_exp_f32 v210, v210
    v_sub_f32 v206, v206, v209
    v_mul_f32 v206, s39, v206
    v_exp_f32 v206, v206
    v_mul_f32 v205, v205, v210
    v_fmac_f32 v205, v207, v206
    v_mov_b32 v207, v205
    s_nop 1
    v_permlane32_swap_b32 v205, v207
    v_add_f32 v205, v205, v207
    v_rcp_f32 v205, v205
    s_nop 0
    v_mul_f32 v210, v210, v205
    v_mul_f32 v206, v206, v205
    v_lshlrev_b32 v6, 13, v5
    v_lshlrev_b32 v7, 4, v4
    v_add_u32 v6, v6, v7
    v_add_u32 v6, s32, v6
    s_lshl_b32 s40, s43, 7
    v_add_u32 v6, s40, v6
    s_waitcnt lgkmcnt(0)
    v_mul_f32 v48, v48, v210
    v_fmac_f32 v48, v112, v206
    v_mul_f32 v49, v49, v210
    v_fmac_f32 v49, v113, v206
    v_mul_f32 v50, v50, v210
    v_fmac_f32 v50, v114, v206
    v_mul_f32 v51, v51, v210
    v_fmac_f32 v51, v115, v206
    v_mul_f32 v52, v52, v210
    v_fmac_f32 v52, v116, v206
    v_mul_f32 v53, v53, v210
    v_fmac_f32 v53, v117, v206
    v_mul_f32 v54, v54, v210
    v_fmac_f32 v54, v118, v206
    v_mul_f32 v55, v55, v210
    v_fmac_f32 v55, v119, v206
    v_cvt_pk_bf16_f32 v48, v48, v49
    v_cvt_pk_bf16_f32 v49, v50, v51
    v_cvt_pk_bf16_f32 v50, v52, v53
    v_cvt_pk_bf16_f32 v51, v54, v55
    s_nop 0
    v_permlane32_swap_b32 v48, v50
    v_permlane32_swap_b32 v49, v51
    buffer_store_dwordx4 v[48:51], v6, s[24:27], 0 offen offset:0
    v_mul_f32 v56, v56, v210
    v_fmac_f32 v56, v120, v206
    v_mul_f32 v57, v57, v210
    v_fmac_f32 v57, v121, v206
    v_mul_f32 v58, v58, v210
    v_fmac_f32 v58, v122, v206
    v_mul_f32 v59, v59, v210
    v_fmac_f32 v59, v123, v206
    v_mul_f32 v60, v60, v210
    v_fmac_f32 v60, v124, v206
    v_mul_f32 v61, v61, v210
    v_fmac_f32 v61, v125, v206
    v_mul_f32 v62, v62, v210
    v_fmac_f32 v62, v126, v206
    v_mul_f32 v63, v63, v210
    v_fmac_f32 v63, v127, v206
    v_cvt_pk_bf16_f32 v56, v56, v57
    v_cvt_pk_bf16_f32 v57, v58, v59
    v_cvt_pk_bf16_f32 v58, v60, v61
    v_cvt_pk_bf16_f32 v59, v62, v63
    s_nop 0
    v_permlane32_swap_b32 v56, v58
    v_permlane32_swap_b32 v57, v59
    buffer_store_dwordx4 v[56:59], v6, s[24:27], 0 offen offset:32
    v_mul_f32 v64, v64, v210
    v_fmac_f32 v64, v128, v206
    v_mul_f32 v65, v65, v210
    v_fmac_f32 v65, v129, v206
    v_mul_f32 v66, v66, v210
    v_fmac_f32 v66, v130, v206
    v_mul_f32 v67, v67, v210
    v_fmac_f32 v67, v131, v206
    v_mul_f32 v68, v68, v210
    v_fmac_f32 v68, v132, v206
    v_mul_f32 v69, v69, v210
    v_fmac_f32 v69, v133, v206
    v_mul_f32 v70, v70, v210
    v_fmac_f32 v70, v134, v206
    v_mul_f32 v71, v71, v210
    v_fmac_f32 v71, v135, v206
    v_cvt_pk_bf16_f32 v64, v64, v65
    v_cvt_pk_bf16_f32 v65, v66, v67
    v_cvt_pk_bf16_f32 v66, v68, v69
    v_cvt_pk_bf16_f32 v67, v70, v71
    s_nop 0
    v_permlane32_swap_b32 v64, v66
    v_permlane32_swap_b32 v65, v67
    buffer_store_dwordx4 v[64:67], v6, s[24:27], 0 offen offset:64
    v_mul_f32 v72, v72, v210
    v_fmac_f32 v72, v136, v206
    v_mul_f32 v73, v73, v210
    v_fmac_f32 v73, v137, v206
    v_mul_f32 v74, v74, v210
    v_fmac_f32 v74, v138, v206
    v_mul_f32 v75, v75, v210
    v_fmac_f32 v75, v139, v206
    v_mul_f32 v76, v76, v210
    v_fmac_f32 v76, v140, v206
    v_mul_f32 v77, v77, v210
    v_fmac_f32 v77, v141, v206
    v_mul_f32 v78, v78, v210
    v_fmac_f32 v78, v142, v206
    v_mul_f32 v79, v79, v210
    v_fmac_f32 v79, v143, v206
    v_cvt_pk_bf16_f32 v72, v72, v73
    v_cvt_pk_bf16_f32 v73, v74, v75
    v_cvt_pk_bf16_f32 v74, v76, v77
    v_cvt_pk_bf16_f32 v75, v78, v79
    s_nop 0
    v_permlane32_swap_b32 v72, v74
    v_permlane32_swap_b32 v73, v75
    buffer_store_dwordx4 v[72:75], v6, s[24:27], 0 offen offset:96
    s_nop 3
.Lattn_kernel_m1:
    s_barrier
    s_cmp_eq_u32 s45, 1
    s_cbranch_scc1 .Lattn_kernel_end2
    s_mov_b32 s45, 1
    s_mov_b32 s29, s44
    s_branch .Lattn_kernel_qblock
.Lattn_kernel_end2:
.Lattn_kernel_end:
    s_endpgm
.globl oproj_kernel
.p2align 8
.type oproj_kernel,@function
oproj_kernel:
    s_cmp_ge_u32 s2, 256
    s_cbranch_scc1 .Loproj_kernel_end
    s_load_dwordx2 s[40:41], s[0:1], 40
    s_load_dwordx2 s[8:9], s[0:1], 104
    s_waitcnt lgkmcnt(0)
    s_and_b32 s46, s2, 15
    s_lshr_b32 s47, s2, 4
    s_and_b32 s47, s47, 3
    s_lshr_b32 s48, s2, 6
    s_add_u32 s12, s8, 0x3400000
    s_addc_u32 s13, s9, 0x0
    s_and_b32 s13, s13, 0xffff
    s_mov_b32 s14, 0x1000000
    s_mov_b32 s15, 0x20000
    s_mov_b32 s16, s40
    s_and_b32 s17, s41, 0xffff
    s_mov_b32 s18, 0x400000
    s_mov_b32 s19, 0x20000
    s_add_u32 s20, s8, 0x5000000
    s_addc_u32 s21, s9, 0x0
    s_and_b32 s21, s21, 0xffff
    s_mov_b32 s22, 0x1000000
    s_mov_b32 s23, 0x20000
    s_mul_i32 s24, s46, 1048576
    s_lshl_b32 s25, s47, 8
    s_lshl_b32 s28, s48, 11
    s_lshl_b32 s29, s48, 20
    s_lshl_b32 s26, s48, 22
    s_mul_i32 s27, s46, 262144
    s_add_u32 s26, s26, s27
    s_lshl_b32 s27, s47, 9
    s_add_u32 s26, s26, s27
    v_and_b32 v1, 63, v0
    v_lshrrev_b32 v2, 6, v0
    s_nop 0
    v_readfirstlane_b32 s52, v2
    s_nop 0
    s_lshl_b32 s53, s52, 10
    v_lshrrev_b32 v3, 3, v1
    v_lshlrev_b32 v4, 3, v2
    v_add_u32 v3, v3, v4
    v_lshrrev_b32 v4, 1, v3
    v_and_b32 v4, 7, v4
    v_and_b32 v5, 7, v1
    v_xor_b32 v4, v4, v5
    v_mul_u32_u24 v5, 8192, v3
    v_lshlrev_b32 v4, 4, v4
    v_add_u32 v5, v5, v4
    v_add_u32 v5, s24, v5
    v_lshrrev_b32 v3, 4, v1
    v_lshrrev_b32 v4, 2, v1
    v_and_b32 v4, 3, v4
    v_xor_b32 v4, v4, v3
    v_lshlrev_b32 v4, 2, v4
    v_and_b32 v6, 3, v1
    v_add_u32 v4, v4, v6
    v_lshlrev_b32 v6, 2, v2
    v_add_u32 v3, v3, v6
    v_mul_u32_u24 v8, 1024, v3
    v_lshlrev_b32 v4, 4, v4
    v_add_u32 v8, v8, v4
    v_add_u32 v8, s25, v8
    v_lshrrev_b32 v3, 1, v2
    v_and_b32 v4, 1, v2
    v_and_b32 v6, 31, v1
    v_lshrrev_b32 v7, 5, v1
    v_lshlrev_b32 v9, 6, v3
    v_add_u32 v9, v9, v6
    v_lshlrev_b32 v9, 7, v9
    v_lshrrev_b32 v14, 1, v6
    v_and_b32 v14, 7, v14
    v_add_u32 v15, 0, v7
    v_xor_b32 v15, v15, v14
    v_lshlrev_b32 v15, 4, v15
    v_add_u32 v10, v9, v15
    v_add_u32 v15, 2, v7
    v_xor_b32 v15, v15, v14
    v_lshlrev_b32 v15, 4, v15
    v_add_u32 v11, v9, v15
    v_add_u32 v15, 4, v7
    v_xor_b32 v15, v15, v14
    v_lshlrev_b32 v15, 4, v15
    v_add_u32 v12, v9, v15
    v_add_u32 v15, 6, v7
    v_xor_b32 v15, v15, v14
    v_lshlrev_b32 v15, 4, v15
    v_add_u32 v13, v9, v15
    v_and_b32 v9, 15, v1
    v_lshrrev_b32 v14, 2, v9
    v_lshlrev_b32 v15, 3, v7
    v_add_u32 v15, v15, v14
    v_lshlrev_b32 v15, 8, v15
    v_and_b32 v9, 3, v9
    v_lshlrev_b32 v9, 3, v9
    v_add_u32 v15, v15, v9
    v_lshrrev_b32 v9, 4, v1
    v_and_b32 v9, 1, v9
    v_lshlrev_b32 v9, 5, v9
    v_add_u32 v15, v15, v9
    v_add_u32 v15, 16384, v15
    v_lshlrev_b32 v9, 1, v4
    v_xor_b32 v7, v9, v14
    v_lshlrev_b32 v7, 6, v7
    v_add_u32 v7, v15, v7
    v_add_u32 v9, 1, v9
    v_xor_b32 v9, v9, v14
    v_lshlrev_b32 v9, 6, v9
    v_add_u32 v15, v15, v9
    s_add_u32 m0, s53, 0
    s_add_u32 s31, s28, 0
    buffer_load_dwordx4 v5, s[12:15], s31 offen lds
    s_add_u32 m0, s53, 4096
    s_add_u32 s31, s28, 262144
    buffer_load_dwordx4 v5, s[12:15], s31 offen lds
    s_add_u32 m0, s53, 8192
    s_add_u32 s31, s28, 524288
    buffer_load_dwordx4 v5, s[12:15], s31 offen lds
    s_add_u32 m0, s53, 12288
    s_add_u32 s31, s28, 786432
    buffer_load_dwordx4 v5, s[12:15], s31 offen lds
    s_add_u32 m0, s53, 16384
    s_add_u32 s31, s29, 0
    buffer_load_dwordx4 v8, s[16:19], s31 offen lds
    s_add_u32 m0, s53, 20480
    s_add_u32 s31, s29, 16384
    buffer_load_dwordx4 v8, s[16:19], s31 offen lds
    s_add_u32 m0, s53, 24576
    s_add_u32 s31, s29, 32768
    buffer_load_dwordx4 v8, s[16:19], s31 offen lds
    s_add_u32 m0, s53, 28672
    s_add_u32 s31, s29, 49152
    buffer_load_dwordx4 v8, s[16:19], s31 offen lds
    s_add_u32 s28, s28, 128
    s_add_u32 s29, s29, 65536
    v_mov_b32 v16, 0
    v_mov_b32 v17, 0
    v_mov_b32 v18, 0
    v_mov_b32 v19, 0
    v_mov_b32 v20, 0
    v_mov_b32 v21, 0
    v_mov_b32 v22, 0
    v_mov_b32 v23, 0
    v_mov_b32 v24, 0
    v_mov_b32 v25, 0
    v_mov_b32 v26, 0
    v_mov_b32 v27, 0
    v_mov_b32 v28, 0
    v_mov_b32 v29, 0
    v_mov_b32 v30, 0
    v_mov_b32 v31, 0
    v_mov_b32 v32, 0
    v_mov_b32 v33, 0
    v_mov_b32 v34, 0
    v_mov_b32 v35, 0
    v_mov_b32 v36, 0
    v_mov_b32 v37, 0
    v_mov_b32 v38, 0
    v_mov_b32 v39, 0
    v_mov_b32 v40, 0
    v_mov_b32 v41, 0
    v_mov_b32 v42, 0
    v_mov_b32 v43, 0
    v_mov_b32 v44, 0
    v_mov_b32 v45, 0
    v_mov_b32 v46, 0
    v_mov_b32 v47, 0
    v_mov_b32 v48, 0
    v_mov_b32 v49, 0
    v_mov_b32 v50, 0
    v_mov_b32 v51, 0
    v_mov_b32 v52, 0
    v_mov_b32 v53, 0
    v_mov_b32 v54, 0
    v_mov_b32 v55, 0
    v_mov_b32 v56, 0
    v_mov_b32 v57, 0
    v_mov_b32 v58, 0
    v_mov_b32 v59, 0
    v_mov_b32 v60, 0
    v_mov_b32 v61, 0
    v_mov_b32 v62, 0
    v_mov_b32 v63, 0
    v_mov_b32 v64, 0
    v_mov_b32 v65, 0
    v_mov_b32 v66, 0
    v_mov_b32 v67, 0
    v_mov_b32 v68, 0
    v_mov_b32 v69, 0
    v_mov_b32 v70, 0
    v_mov_b32 v71, 0
    v_mov_b32 v72, 0
    v_mov_b32 v73, 0
    v_mov_b32 v74, 0
    v_mov_b32 v75, 0
    v_mov_b32 v76, 0
    v_mov_b32 v77, 0
    v_mov_b32 v78, 0
    v_mov_b32 v79, 0
    s_mov_b32 s30, 8
    s_nop 3
.Loproj_kernel_loop:
    s_waitcnt vmcnt(0)
    s_barrier
    ds_read_b128 v[80:83], v10 offset:0
    ds_read_b128 v[84:87], v10 offset:4096
    ds_read_b64_tr_b16 v[96:97], v7 offset:0
    ds_read_b64_tr_b16 v[98:99], v7 offset:1024
    ds_read_b64_tr_b16 v[100:101], v15 offset:0
    ds_read_b64_tr_b16 v[102:103], v15 offset:1024
    ds_read_b128 v[88:91], v11 offset:0
    ds_read_b128 v[92:95], v11 offset:4096
    ds_read_b64_tr_b16 v[104:105], v7 offset:4096
    ds_read_b64_tr_b16 v[106:107], v7 offset:5120
    ds_read_b64_tr_b16 v[108:109], v15 offset:4096
    ds_read_b64_tr_b16 v[110:111], v15 offset:5120
    s_waitcnt lgkmcnt(6)
    v_mfma_f32_32x32x16_bf16 v[16:31], v[96:99], v[80:83], v[16:31]
    s_add_u32 m0, s53, 32768
    s_add_u32 s31, s28, 0
    buffer_load_dwordx4 v5, s[12:15], s31 offen lds
    v_mfma_f32_32x32x16_bf16 v[32:47], v[100:103], v[80:83], v[32:47]
    s_add_u32 m0, s53, 36864
    s_add_u32 s31, s28, 262144
    buffer_load_dwordx4 v5, s[12:15], s31 offen lds
    v_mfma_f32_32x32x16_bf16 v[48:63], v[96:99], v[84:87], v[48:63]
    s_add_u32 m0, s53, 40960
    s_add_u32 s31, s28, 524288
    buffer_load_dwordx4 v5, s[12:15], s31 offen lds
    v_mfma_f32_32x32x16_bf16 v[64:79], v[100:103], v[84:87], v[64:79]
    s_add_u32 m0, s53, 45056
    s_add_u32 s31, s28, 786432
    buffer_load_dwordx4 v5, s[12:15], s31 offen lds
    ds_read_b128 v[80:83], v12 offset:0
    ds_read_b128 v[84:87], v12 offset:4096
    ds_read_b64_tr_b16 v[96:97], v7 offset:8192
    ds_read_b64_tr_b16 v[98:99], v7 offset:9216
    ds_read_b64_tr_b16 v[100:101], v15 offset:8192
    ds_read_b64_tr_b16 v[102:103], v15 offset:9216
    s_waitcnt lgkmcnt(6)
    v_mfma_f32_32x32x16_bf16 v[16:31], v[104:107], v[88:91], v[16:31]
    s_add_u32 m0, s53, 49152
    s_add_u32 s31, s29, 0
    buffer_load_dwordx4 v8, s[16:19], s31 offen lds
    v_mfma_f32_32x32x16_bf16 v[32:47], v[108:111], v[88:91], v[32:47]
    s_add_u32 m0, s53, 53248
    s_add_u32 s31, s29, 16384
    buffer_load_dwordx4 v8, s[16:19], s31 offen lds
    v_mfma_f32_32x32x16_bf16 v[48:63], v[104:107], v[92:95], v[48:63]
    s_add_u32 m0, s53, 57344
    s_add_u32 s31, s29, 32768
    buffer_load_dwordx4 v8, s[16:19], s31 offen lds
    v_mfma_f32_32x32x16_bf16 v[64:79], v[108:111], v[92:95], v[64:79]
    s_add_u32 m0, s53, 61440
    s_add_u32 s31, s29, 49152
    buffer_load_dwordx4 v8, s[16:19], s31 offen lds
    s_add_u32 s28, s28, 128
    s_add_u32 s29, s29, 65536
    ds_read_b128 v[88:91], v13 offset:0
    ds_read_b128 v[92:95], v13 offset:4096
    ds_read_b64_tr_b16 v[104:105], v7 offset:12288
    ds_read_b64_tr_b16 v[106:107], v7 offset:13312
    ds_read_b64_tr_b16 v[108:109], v15 offset:12288
    ds_read_b64_tr_b16 v[110:111], v15 offset:13312
    s_waitcnt lgkmcnt(6)
    v_mfma_f32_32x32x16_bf16 v[16:31], v[96:99], v[80:83], v[16:31]
    v_mfma_f32_32x32x16_bf16 v[32:47], v[100:103], v[80:83], v[32:47]
    v_mfma_f32_32x32x16_bf16 v[48:63], v[96:99], v[84:87], v[48:63]
    v_mfma_f32_32x32x16_bf16 v[64:79], v[100:103], v[84:87], v[64:79]
    s_waitcnt lgkmcnt(0)
    v_mfma_f32_32x32x16_bf16 v[16:31], v[104:107], v[88:91], v[16:31]
    v_mfma_f32_32x32x16_bf16 v[32:47], v[108:111], v[88:91], v[32:47]
    v_mfma_f32_32x32x16_bf16 v[48:63], v[104:107], v[92:95], v[48:63]
    v_mfma_f32_32x32x16_bf16 v[64:79], v[108:111], v[92:95], v[64:79]
    s_waitcnt vmcnt(0)
    s_barrier
    ds_read_b128 v[80:83], v10 offset:32768
    ds_read_b128 v[84:87], v10 offset:36864
    ds_read_b64_tr_b16 v[96:97], v7 offset:32768
    ds_read_b64_tr_b16 v[98:99], v7 offset:33792
    ds_read_b64_tr_b16 v[100:101], v15 offset:32768
    ds_read_b64_tr_b16 v[102:103], v15 offset:33792
    ds_read_b128 v[88:91], v11 offset:32768
    ds_read_b128 v[92:95], v11 offset:36864
    ds_read_b64_tr_b16 v[104:105], v7 offset:36864
    ds_read_b64_tr_b16 v[106:107], v7 offset:37888
    ds_read_b64_tr_b16 v[108:109], v15 offset:36864
    ds_read_b64_tr_b16 v[110:111], v15 offset:37888
    s_waitcnt lgkmcnt(6)
    v_mfma_f32_32x32x16_bf16 v[16:31], v[96:99], v[80:83], v[16:31]
    s_add_u32 m0, s53, 0
    s_add_u32 s31, s28, 0
    buffer_load_dwordx4 v5, s[12:15], s31 offen lds
    v_mfma_f32_32x32x16_bf16 v[32:47], v[100:103], v[80:83], v[32:47]
    s_add_u32 m0, s53, 4096
    s_add_u32 s31, s28, 262144
    buffer_load_dwordx4 v5, s[12:15], s31 offen lds
    v_mfma_f32_32x32x16_bf16 v[48:63], v[96:99], v[84:87], v[48:63]
    s_add_u32 m0, s53, 8192
    s_add_u32 s31, s28, 524288
    buffer_load_dwordx4 v5, s[12:15], s31 offen lds
    v_mfma_f32_32x32x16_bf16 v[64:79], v[100:103], v[84:87], v[64:79]
    s_add_u32 m0, s53, 12288
    s_add_u32 s31, s28, 786432
    buffer_load_dwordx4 v5, s[12:15], s31 offen lds
    ds_read_b128 v[80:83], v12 offset:32768
    ds_read_b128 v[84:87], v12 offset:36864
    ds_read_b64_tr_b16 v[96:97], v7 offset:40960
    ds_read_b64_tr_b16 v[98:99], v7 offset:41984
    ds_read_b64_tr_b16 v[100:101], v15 offset:40960
    ds_read_b64_tr_b16 v[102:103], v15 offset:41984
    s_waitcnt lgkmcnt(6)
    v_mfma_f32_32x32x16_bf16 v[16:31], v[104:107], v[88:91], v[16:31]
    s_add_u32 m0, s53, 16384
    s_add_u32 s31, s29, 0
    buffer_load_dwordx4 v8, s[16:19], s31 offen lds
    v_mfma_f32_32x32x16_bf16 v[32:47], v[108:111], v[88:91], v[32:47]
    s_add_u32 m0, s53, 20480
    s_add_u32 s31, s29, 16384
    buffer_load_dwordx4 v8, s[16:19], s31 offen lds
    v_mfma_f32_32x32x16_bf16 v[48:63], v[104:107], v[92:95], v[48:63]
    s_add_u32 m0, s53, 24576
    s_add_u32 s31, s29, 32768
    buffer_load_dwordx4 v8, s[16:19], s31 offen lds
    v_mfma_f32_32x32x16_bf16 v[64:79], v[108:111], v[92:95], v[64:79]
    s_add_u32 m0, s53, 28672
    s_add_u32 s31, s29, 49152
    buffer_load_dwordx4 v8, s[16:19], s31 offen lds
    s_add_u32 s28, s28, 128
    s_add_u32 s29, s29, 65536
    ds_read_b128 v[88:91], v13 offset:32768
    ds_read_b128 v[92:95], v13 offset:36864
    ds_read_b64_tr_b16 v[104:105], v7 offset:45056
    ds_read_b64_tr_b16 v[106:107], v7 offset:46080
    ds_read_b64_tr_b16 v[108:109], v15 offset:45056
    ds_read_b64_tr_b16 v[110:111], v15 offset:46080
    s_waitcnt lgkmcnt(6)
    v_mfma_f32_32x32x16_bf16 v[16:31], v[96:99], v[80:83], v[16:31]
    v_mfma_f32_32x32x16_bf16 v[32:47], v[100:103], v[80:83], v[32:47]
    v_mfma_f32_32x32x16_bf16 v[48:63], v[96:99], v[84:87], v[48:63]
    v_mfma_f32_32x32x16_bf16 v[64:79], v[100:103], v[84:87], v[64:79]
    s_waitcnt lgkmcnt(0)
    v_mfma_f32_32x32x16_bf16 v[16:31], v[104:107], v[88:91], v[16:31]
    v_mfma_f32_32x32x16_bf16 v[32:47], v[108:111], v[88:91], v[32:47]
    v_mfma_f32_32x32x16_bf16 v[48:63], v[104:107], v[92:95], v[48:63]
    v_mfma_f32_32x32x16_bf16 v[64:79], v[108:111], v[92:95], v[64:79]
    s_sub_u32 s30, s30, 1
    s_cmp_lg_u32 s30, 0
    s_nop 9
    s_cbranch_scc1 .Loproj_kernel_loop
    s_waitcnt vmcnt(0)
    v_lshlrev_b32 v5, 6, v3
    v_add_u32 v5, v5, v6
    v_lshlrev_b32 v7, 6, v4
    v_lshrrev_b32 v8, 5, v1
    v_lshlrev_b32 v8, 2, v8
    v_add_u32 v7, v7, v8
    s_barrier
    v_mul_u32_u24 v9, 528, v5
    v_lshlrev_b32 v10, 2, v7
    v_add_u32 v9, v9, v10
    ds_write_b128 v9, v[16:19] offset:0
    ds_write_b128 v9, v[20:23] offset:32
    ds_write_b128 v9, v[24:27] offset:64
    ds_write_b128 v9, v[28:31] offset:96
    ds_write_b128 v9, v[32:35] offset:128
    ds_write_b128 v9, v[36:39] offset:160
    ds_write_b128 v9, v[40:43] offset:192
    ds_write_b128 v9, v[44:47] offset:224
    ds_write_b128 v9, v[48:51] offset:16896
    ds_write_b128 v9, v[52:55] offset:16928
    ds_write_b128 v9, v[56:59] offset:16960
    ds_write_b128 v9, v[60:63] offset:16992
    ds_write_b128 v9, v[64:67] offset:17024
    ds_write_b128 v9, v[68:71] offset:17056
    ds_write_b128 v9, v[72:75] offset:17088
    ds_write_b128 v9, v[76:79] offset:17120
    v_lshrrev_b32 v3, 5, v0
    v_and_b32 v4, 31, v0
    v_lshlrev_b32 v4, 4, v4
    v_mul_u32_u24 v9, 528, v3
    v_add_u32 v9, v9, v4
    v_mul_u32_u24 v10, 2048, v3
    v_add_u32 v10, v10, v4
    v_add_u32 v10, s26, v10
    s_waitcnt lgkmcnt(0)
    s_barrier
    ds_read_b128 v[16:19], v9 offset:0
    ds_read_b128 v[20:23], v9 offset:4224
    ds_read_b128 v[24:27], v9 offset:8448
    ds_read_b128 v[28:31], v9 offset:12672
    ds_read_b128 v[32:35], v9 offset:16896
    ds_read_b128 v[36:39], v9 offset:21120
    ds_read_b128 v[40:43], v9 offset:25344
    ds_read_b128 v[44:47], v9 offset:29568
    ds_read_b128 v[48:51], v9 offset:33792
    ds_read_b128 v[52:55], v9 offset:38016
    ds_read_b128 v[56:59], v9 offset:42240
    ds_read_b128 v[60:63], v9 offset:46464
    ds_read_b128 v[64:67], v9 offset:50688
    ds_read_b128 v[68:71], v9 offset:54912
    ds_read_b128 v[72:75], v9 offset:59136
    ds_read_b128 v[76:79], v9 offset:63360
    s_waitcnt lgkmcnt(15)
    s_mov_b32 s31, 0
    buffer_store_dwordx4 v[16:19], v10, s[20:23], s31 offen
    s_waitcnt lgkmcnt(14)
    s_mov_b32 s31, 16384
    buffer_store_dwordx4 v[20:23], v10, s[20:23], s31 offen
    s_waitcnt lgkmcnt(13)
    s_mov_b32 s31, 32768
    buffer_store_dwordx4 v[24:27], v10, s[20:23], s31 offen
    s_waitcnt lgkmcnt(12)
    s_mov_b32 s31, 49152
    buffer_store_dwordx4 v[28:31], v10, s[20:23], s31 offen
    s_waitcnt lgkmcnt(11)
    s_mov_b32 s31, 65536
    buffer_store_dwordx4 v[32:35], v10, s[20:23], s31 offen
    s_waitcnt lgkmcnt(10)
    s_mov_b32 s31, 81920
    buffer_store_dwordx4 v[36:39], v10, s[20:23], s31 offen
    s_waitcnt lgkmcnt(9)
    s_mov_b32 s31, 98304
    buffer_store_dwordx4 v[40:43], v10, s[20:23], s31 offen
    s_waitcnt lgkmcnt(8)
    s_mov_b32 s31, 114688
    buffer_store_dwordx4 v[44:47], v10, s[20:23], s31 offen
    s_waitcnt lgkmcnt(7)
    s_mov_b32 s31, 131072
    buffer_store_dwordx4 v[48:51], v10, s[20:23], s31 offen
    s_waitcnt lgkmcnt(6)
    s_mov_b32 s31, 147456
    buffer_store_dwordx4 v[52:55], v10, s[20:23], s31 offen
    s_waitcnt lgkmcnt(5)
    s_mov_b32 s31, 163840
    buffer_store_dwordx4 v[56:59], v10, s[20:23], s31 offen
    s_waitcnt lgkmcnt(4)
    s_mov_b32 s31, 180224
    buffer_store_dwordx4 v[60:63], v10, s[20:23], s31 offen
    s_waitcnt lgkmcnt(3)
    s_mov_b32 s31, 196608
    buffer_store_dwordx4 v[64:67], v10, s[20:23], s31 offen
    s_waitcnt lgkmcnt(2)
    s_mov_b32 s31, 212992
    buffer_store_dwordx4 v[68:71], v10, s[20:23], s31 offen
    s_waitcnt lgkmcnt(1)
    s_mov_b32 s31, 229376
    buffer_store_dwordx4 v[72:75], v10, s[20:23], s31 offen
    s_waitcnt lgkmcnt(0)
    s_mov_b32 s31, 245760
    buffer_store_dwordx4 v[76:79], v10, s[20:23], s31 offen
    s_nop 1
.Loproj_kernel_end:
    s_endpgm
.globl ln2_kernel
.p2align 8
.type ln2_kernel,@function
ln2_kernel:
    s_cmp_ge_u32 s2, 512
    s_cbranch_scc1 .Lln2_kernel_end
    s_load_dwordx2 s[4:5], s[0:1], 0
    s_load_dwordx2 s[8:9], s[0:1], 104
    s_waitcnt lgkmcnt(0)
    s_mov_b32 s12, s4
    s_and_b32 s13, s5, 0xffff
    s_mov_b32 s14, 0x200000
    s_mov_b32 s15, 0x20000
    s_mov_b32 s16, s8
    s_and_b32 s17, s9, 0xffff
    s_mov_b32 s18, 0x3000
    s_mov_b32 s19, 0x20000
    s_add_u32 s20, s8, 0x4600000
    s_addc_u32 s21, s9, 0x0
    s_and_b32 s21, s21, 0xffff
    s_mov_b32 s22, 0x200000
    s_mov_b32 s23, 0x20000
    v_and_b32 v1, 63, v0
    v_lshrrev_b32 v2, 6, v0
    s_lshl_b32 s24, s2, 2
    v_add_u32 v2, s24, v2
    v_lshlrev_b32 v3, 10, v2
    v_lshlrev_b32 v4, 4, v1
    v_add_u32 v3, v3, v4
    buffer_load_dwordx4 v[8:11], v3, s[12:15], 0 offen
    v_lshlrev_b32 v5, 5, v1
    s_add_u32 s24, s8, 0x5000000
    s_addc_u32 s25, s9, 0x0
    s_and_b32 s25, s25, 0xffff
    s_mov_b32 s26, 0x1000000
    s_mov_b32 s27, 0x20000
    s_add_u32 s28, s8, 0x4400000
    s_addc_u32 s29, s9, 0x0
    s_and_b32 s29, s29, 0xffff
    s_mov_b32 s30, 0x200000
    s_mov_b32 s31, 0x20000
    v_lshlrev_b32 v6, 1, v3
    s_mov_b32 s33, 0
    buffer_load_dwordx4 v[56:59], v6, s[24:27], s33 offen
    buffer_load_dwordx4 v[60:63], v6, s[24:27], s33 offen offset:16
    s_mov_b32 s33, 4194304
    buffer_load_dwordx4 v[64:67], v6, s[24:27], s33 offen
    buffer_load_dwordx4 v[68:71], v6, s[24:27], s33 offen offset:16
    s_mov_b32 s33, 8388608
    buffer_load_dwordx4 v[72:75], v6, s[24:27], s33 offen
    buffer_load_dwordx4 v[76:79], v6, s[24:27], s33 offen offset:16
    s_mov_b32 s33, 12582912
    buffer_load_dwordx4 v[80:83], v6, s[24:27], s33 offen
    buffer_load_dwordx4 v[84:87], v6, s[24:27], s33 offen offset:16
    v_add_u32 v6, 4096, v5
    buffer_load_dwordx4 v[40:43], v6, s[16:19], 0 offen
    buffer_load_dwordx4 v[44:47], v6, s[16:19], 0 offen offset:16
    s_waitcnt vmcnt(0)
    v_lshlrev_b32 v16, 16, v8
    v_and_b32 v17, 0xffff0000, v8
    v_lshlrev_b32 v18, 16, v9
    v_and_b32 v19, 0xffff0000, v9
    v_lshlrev_b32 v20, 16, v10
    v_and_b32 v21, 0xffff0000, v10
    v_lshlrev_b32 v22, 16, v11
    v_and_b32 v23, 0xffff0000, v11
    v_add_f32 v56, v56, v64
    v_add_f32 v72, v72, v80
    v_add_f32 v56, v56, v72
    v_cvt_pk_bf16_f32 v56, v56, v56
    v_lshlrev_b32 v56, 16, v56
    v_mul_f32 v56, v56, v40
    v_cvt_pk_bf16_f32 v56, v56, v56
    v_lshlrev_b32 v56, 16, v56
    v_add_f32 v16, v16, v56
    v_add_f32 v57, v57, v65
    v_add_f32 v73, v73, v81
    v_add_f32 v57, v57, v73
    v_cvt_pk_bf16_f32 v57, v57, v57
    v_lshlrev_b32 v57, 16, v57
    v_mul_f32 v57, v57, v41
    v_cvt_pk_bf16_f32 v57, v57, v57
    v_lshlrev_b32 v57, 16, v57
    v_add_f32 v17, v17, v57
    v_add_f32 v58, v58, v66
    v_add_f32 v74, v74, v82
    v_add_f32 v58, v58, v74
    v_cvt_pk_bf16_f32 v58, v58, v58
    v_lshlrev_b32 v58, 16, v58
    v_mul_f32 v58, v58, v42
    v_cvt_pk_bf16_f32 v58, v58, v58
    v_lshlrev_b32 v58, 16, v58
    v_add_f32 v18, v18, v58
    v_add_f32 v59, v59, v67
    v_add_f32 v75, v75, v83
    v_add_f32 v59, v59, v75
    v_cvt_pk_bf16_f32 v59, v59, v59
    v_lshlrev_b32 v59, 16, v59
    v_mul_f32 v59, v59, v43
    v_cvt_pk_bf16_f32 v59, v59, v59
    v_lshlrev_b32 v59, 16, v59
    v_add_f32 v19, v19, v59
    v_add_f32 v60, v60, v68
    v_add_f32 v76, v76, v84
    v_add_f32 v60, v60, v76
    v_cvt_pk_bf16_f32 v60, v60, v60
    v_lshlrev_b32 v60, 16, v60
    v_mul_f32 v60, v60, v44
    v_cvt_pk_bf16_f32 v60, v60, v60
    v_lshlrev_b32 v60, 16, v60
    v_add_f32 v20, v20, v60
    v_add_f32 v61, v61, v69
    v_add_f32 v77, v77, v85
    v_add_f32 v61, v61, v77
    v_cvt_pk_bf16_f32 v61, v61, v61
    v_lshlrev_b32 v61, 16, v61
    v_mul_f32 v61, v61, v45
    v_cvt_pk_bf16_f32 v61, v61, v61
    v_lshlrev_b32 v61, 16, v61
    v_add_f32 v21, v21, v61
    v_add_f32 v62, v62, v70
    v_add_f32 v78, v78, v86
    v_add_f32 v62, v62, v78
    v_cvt_pk_bf16_f32 v62, v62, v62
    v_lshlrev_b32 v62, 16, v62
    v_mul_f32 v62, v62, v46
    v_cvt_pk_bf16_f32 v62, v62, v62
    v_lshlrev_b32 v62, 16, v62
    v_add_f32 v22, v22, v62
    v_add_f32 v63, v63, v71
    v_add_f32 v79, v79, v87
    v_add_f32 v63, v63, v79
    v_cvt_pk_bf16_f32 v63, v63, v63
    v_lshlrev_b32 v63, 16, v63
    v_mul_f32 v63, v63, v47
    v_cvt_pk_bf16_f32 v63, v63, v63
    v_lshlrev_b32 v63, 16, v63
    v_add_f32 v23, v23, v63
    v_cvt_pk_bf16_f32 v8, v16, v17
    v_cvt_pk_bf16_f32 v9, v18, v19
    v_cvt_pk_bf16_f32 v10, v20, v21
    v_cvt_pk_bf16_f32 v11, v22, v23
    buffer_store_dwordx4 v[8:11], v3, s[28:31], 0 offen
    v_add_u32 v6, 8192, v5
    buffer_load_dwordx4 v[40:43], v6, s[16:19], 0 offen
    buffer_load_dwordx4 v[44:47], v6, s[16:19], 0 offen offset:16
    v_add_u32 v6, 6144, v5
    buffer_load_dwordx4 v[48:51], v6, s[16:19], 0 offen
    buffer_load_dwordx4 v[52:55], v6, s[16:19], 0 offen offset:16
    s_waitcnt vmcnt(4)
    v_lshlrev_b32 v16, 16, v8
    v_and_b32 v17, 0xffff0000, v8
    v_lshlrev_b32 v18, 16, v9
    v_and_b32 v19, 0xffff0000, v9
    v_lshlrev_b32 v20, 16, v10
    v_and_b32 v21, 0xffff0000, v10
    v_lshlrev_b32 v22, 16, v11
    v_and_b32 v23, 0xffff0000, v11
    v_add_f32 v24, v16, v17
    v_add_f32 v24, v24, v18
    v_add_f32 v24, v24, v19
    v_add_f32 v24, v24, v20
    v_add_f32 v24, v24, v21
    v_add_f32 v24, v24, v22
    v_add_f32 v24, v24, v23
    ds_swizzle_b32 v25, v24 offset:0x41f
    s_waitcnt lgkmcnt(0)
    v_add_f32 v24, v24, v25
    ds_swizzle_b32 v25, v24 offset:0x81f
    s_waitcnt lgkmcnt(0)
    v_add_f32 v24, v24, v25
    ds_swizzle_b32 v25, v24 offset:0x101f
    s_waitcnt lgkmcnt(0)
    v_add_f32 v24, v24, v25
    ds_swizzle_b32 v25, v24 offset:0x201f
    s_waitcnt lgkmcnt(0)
    v_add_f32 v24, v24, v25
    ds_swizzle_b32 v25, v24 offset:0x401f
    s_waitcnt lgkmcnt(0)
    v_add_f32 v24, v24, v25
    v_mov_b32 v25, v24
    s_nop 1
    v_permlane32_swap_b32 v24, v25
    v_add_f32 v24, v24, v25
    v_mul_f32 v24, 0x3b000000, v24
    v_mov_b32 v26, 0
    v_sub_f32 v27, v16, v24
    v_fmac_f32 v26, v27, v27
    v_sub_f32 v27, v17, v24
    v_fmac_f32 v26, v27, v27
    v_sub_f32 v27, v18, v24
    v_fmac_f32 v26, v27, v27
    v_sub_f32 v27, v19, v24
    v_fmac_f32 v26, v27, v27
    v_sub_f32 v27, v20, v24
    v_fmac_f32 v26, v27, v27
    v_sub_f32 v27, v21, v24
    v_fmac_f32 v26, v27, v27
    v_sub_f32 v27, v22, v24
    v_fmac_f32 v26, v27, v27
    v_sub_f32 v27, v23, v24
    v_fmac_f32 v26, v27, v27
    ds_swizzle_b32 v25, v26 offset:0x41f
    s_waitcnt lgkmcnt(0)
    v_add_f32 v26, v26, v25
    ds_swizzle_b32 v25, v26 offset:0x81f
    s_waitcnt lgkmcnt(0)
    v_add_f32 v26, v26, v25
    ds_swizzle_b32 v25, v26 offset:0x101f
    s_waitcnt lgkmcnt(0)
    v_add_f32 v26, v26, v25
    ds_swizzle_b32 v25, v26 offset:0x201f
    s_waitcnt lgkmcnt(0)
    v_add_f32 v26, v26, v25
    ds_swizzle_b32 v25, v26 offset:0x401f
    s_waitcnt lgkmcnt(0)
    v_add_f32 v26, v26, v25
    v_mov_b32 v25, v26
    s_nop 1
    v_permlane32_swap_b32 v26, v25
    v_add_f32 v26, v26, v25
    v_mul_f32 v26, 0x3b000000, v26
    v_cvt_pk_bf16_f32 v24, v24, v24
    v_lshlrev_b32 v24, 16, v24
    v_cvt_pk_bf16_f32 v26, v26, v26
    v_lshlrev_b32 v26, 16, v26
    v_add_f32 v26, 0x3727c5ac, v26
    v_cvt_pk_bf16_f32 v26, v26, v26
    v_lshlrev_b32 v26, 16, v26
    v_sqrt_f32 v26, v26
    s_nop 0
    v_cvt_pk_bf16_f32 v26, v26, v26
    v_lshlrev_b32 v26, 16, v26
    v_rcp_f32 v26, v26
    s_waitcnt vmcnt(0)
    v_sub_f32 v16, v16, v24
    v_cvt_pk_bf16_f32 v16, v16, v16
    v_lshlrev_b32 v16, 16, v16
    v_mul_f32 v16, v16, v26
    v_cvt_pk_bf16_f32 v16, v16, v16
    v_lshlrev_b32 v16, 16, v16
    v_add_f32 v40, 1.0, v40
    v_cvt_pk_bf16_f32 v40, v40, v40
    v_lshlrev_b32 v40, 16, v40
    v_mul_f32 v16, v16, v40
    v_cvt_pk_bf16_f32 v16, v16, v16
    v_lshlrev_b32 v16, 16, v16
    v_add_f32 v16, v16, v48
    v_sub_f32 v17, v17, v24
    v_cvt_pk_bf16_f32 v17, v17, v17
    v_lshlrev_b32 v17, 16, v17
    v_mul_f32 v17, v17, v26
    v_cvt_pk_bf16_f32 v17, v17, v17
    v_lshlrev_b32 v17, 16, v17
    v_add_f32 v41, 1.0, v41
    v_cvt_pk_bf16_f32 v41, v41, v41
    v_lshlrev_b32 v41, 16, v41
    v_mul_f32 v17, v17, v41
    v_cvt_pk_bf16_f32 v17, v17, v17
    v_lshlrev_b32 v17, 16, v17
    v_add_f32 v17, v17, v49
    v_sub_f32 v18, v18, v24
    v_cvt_pk_bf16_f32 v18, v18, v18
    v_lshlrev_b32 v18, 16, v18
    v_mul_f32 v18, v18, v26
    v_cvt_pk_bf16_f32 v18, v18, v18
    v_lshlrev_b32 v18, 16, v18
    v_add_f32 v42, 1.0, v42
    v_cvt_pk_bf16_f32 v42, v42, v42
    v_lshlrev_b32 v42, 16, v42
    v_mul_f32 v18, v18, v42
    v_cvt_pk_bf16_f32 v18, v18, v18
    v_lshlrev_b32 v18, 16, v18
    v_add_f32 v18, v18, v50
    v_sub_f32 v19, v19, v24
    v_cvt_pk_bf16_f32 v19, v19, v19
    v_lshlrev_b32 v19, 16, v19
    v_mul_f32 v19, v19, v26
    v_cvt_pk_bf16_f32 v19, v19, v19
    v_lshlrev_b32 v19, 16, v19
    v_add_f32 v43, 1.0, v43
    v_cvt_pk_bf16_f32 v43, v43, v43
    v_lshlrev_b32 v43, 16, v43
    v_mul_f32 v19, v19, v43
    v_cvt_pk_bf16_f32 v19, v19, v19
    v_lshlrev_b32 v19, 16, v19
    v_add_f32 v19, v19, v51
    v_sub_f32 v20, v20, v24
    v_cvt_pk_bf16_f32 v20, v20, v20
    v_lshlrev_b32 v20, 16, v20
    v_mul_f32 v20, v20, v26
    v_cvt_pk_bf16_f32 v20, v20, v20
    v_lshlrev_b32 v20, 16, v20
    v_add_f32 v44, 1.0, v44
    v_cvt_pk_bf16_f32 v44, v44, v44
    v_lshlrev_b32 v44, 16, v44
    v_mul_f32 v20, v20, v44
    v_cvt_pk_bf16_f32 v20, v20, v20
    v_lshlrev_b32 v20, 16, v20
    v_add_f32 v20, v20, v52
    v_sub_f32 v21, v21, v24
    v_cvt_pk_bf16_f32 v21, v21, v21
    v_lshlrev_b32 v21, 16, v21
    v_mul_f32 v21, v21, v26
    v_cvt_pk_bf16_f32 v21, v21, v21
    v_lshlrev_b32 v21, 16, v21
    v_add_f32 v45, 1.0, v45
    v_cvt_pk_bf16_f32 v45, v45, v45
    v_lshlrev_b32 v45, 16, v45
    v_mul_f32 v21, v21, v45
    v_cvt_pk_bf16_f32 v21, v21, v21
    v_lshlrev_b32 v21, 16, v21
    v_add_f32 v21, v21, v53
    v_sub_f32 v22, v22, v24
    v_cvt_pk_bf16_f32 v22, v22, v22
    v_lshlrev_b32 v22, 16, v22
    v_mul_f32 v22, v22, v26
    v_cvt_pk_bf16_f32 v22, v22, v22
    v_lshlrev_b32 v22, 16, v22
    v_add_f32 v46, 1.0, v46
    v_cvt_pk_bf16_f32 v46, v46, v46
    v_lshlrev_b32 v46, 16, v46
    v_mul_f32 v22, v22, v46
    v_cvt_pk_bf16_f32 v22, v22, v22
    v_lshlrev_b32 v22, 16, v22
    v_add_f32 v22, v22, v54
    v_sub_f32 v23, v23, v24
    v_cvt_pk_bf16_f32 v23, v23, v23
    v_lshlrev_b32 v23, 16, v23
    v_mul_f32 v23, v23, v26
    v_cvt_pk_bf16_f32 v23, v23, v23
    v_lshlrev_b32 v23, 16, v23
    v_add_f32 v47, 1.0, v47
    v_cvt_pk_bf16_f32 v47, v47, v47
    v_lshlrev_b32 v47, 16, v47
    v_mul_f32 v23, v23, v47
    v_cvt_pk_bf16_f32 v23, v23, v23
    v_lshlrev_b32 v23, 16, v23
    v_add_f32 v23, v23, v55
    v_cvt_pk_bf16_f32 v8, v16, v17
    v_cvt_pk_bf16_f32 v9, v18, v19
    v_cvt_pk_bf16_f32 v10, v20, v21
    v_cvt_pk_bf16_f32 v11, v22, v23
    buffer_store_dwordx4 v[8:11], v3, s[20:23], 0 offen
    s_nop 3
.Lln2_kernel_end:
    s_endpgm
.globl ffn1_kernel
.p2align 8
.type ffn1_kernel,@function
ffn1_kernel:
    s_cmp_ge_u32 s2, 224
    s_cbranch_scc1 .Lffn1_kernel_end
    s_load_dwordx2 s[40:41], s[0:1], 56
    s_load_dwordx2 s[8:9], s[0:1], 104
    s_waitcnt lgkmcnt(0)
    s_and_b32 s46, s2, 15
    s_lshr_b32 s47, s2, 4
    s_add_u32 s12, s8, 0x4600000
    s_addc_u32 s13, s9, 0x0
    s_and_b32 s13, s13, 0xffff
    s_mov_b32 s14, 0x200000
    s_mov_b32 s15, 0x20000
    s_mov_b32 s16, s40
    s_and_b32 s17, s41, 0xffff
    s_mov_b32 s18, 0x1c0000
    s_mov_b32 s19, 0x20000
    s_add_u32 s20, s8, 0x4800000
    s_addc_u32 s21, s9, 0x0
    s_and_b32 s21, s21, 0xffff
    s_mov_b32 s22, 0x700000
    s_mov_b32 s23, 0x20000
    s_mul_i32 s24, s46, 131072
    s_lshl_b32 s25, s47, 8
    s_mul_i32 s26, s46, 458752
    s_add_u32 s26, s26, s25
    s_mov_b32 s28, 0
    s_mov_b32 s29, 0
    v_and_b32 v1, 63, v0
    v_lshrrev_b32 v2, 6, v0
    s_nop 0
    v_readfirstlane_b32 s52, v2
    s_nop 0
    s_lshl_b32 s53, s52, 10
    v_lshrrev_b32 v3, 3, v1
    v_lshlrev_b32 v4, 3, v2
    v_add_u32 v3, v3, v4
    v_lshrrev_b32 v4, 1, v3
    v_and_b32 v4, 7, v4
    v_and_b32 v5, 7, v1
    v_xor_b32 v4, v4, v5
    v_mul_u32_u24 v5, 1024, v3
    v_lshlrev_b32 v4, 4, v4
    v_add_u32 v5, v5, v4
    v_add_u32 v5, s24, v5
    v_lshrrev_b32 v3, 4, v1
    v_lshrrev_b32 v4, 2, v1
    v_and_b32 v4, 3, v4
    v_xor_b32 v4, v4, v3
    v_lshlrev_b32 v4, 2, v4
    v_and_b32 v6, 3, v1
    v_add_u32 v4, v4, v6
    v_lshlrev_b32 v6, 2, v2
    v_add_u32 v3, v3, v6
    v_mul_u32_u24 v8, 3584, v3
    v_lshlrev_b32 v4, 4, v4
    v_add_u32 v8, v8, v4
    v_add_u32 v8, s25, v8
    v_lshrrev_b32 v3, 1, v2
    v_and_b32 v4, 1, v2
    v_and_b32 v6, 31, v1
    v_lshrrev_b32 v7, 5, v1
    v_lshlrev_b32 v9, 6, v3
    v_add_u32 v9, v9, v6
    v_lshlrev_b32 v9, 7, v9
    v_lshrrev_b32 v14, 1, v6
    v_and_b32 v14, 7, v14
    v_add_u32 v15, 0, v7
    v_xor_b32 v15, v15, v14
    v_lshlrev_b32 v15, 4, v15
    v_add_u32 v10, v9, v15
    v_add_u32 v15, 2, v7
    v_xor_b32 v15, v15, v14
    v_lshlrev_b32 v15, 4, v15
    v_add_u32 v11, v9, v15
    v_add_u32 v15, 4, v7
    v_xor_b32 v15, v15, v14
    v_lshlrev_b32 v15, 4, v15
    v_add_u32 v12, v9, v15
    v_add_u32 v15, 6, v7
    v_xor_b32 v15, v15, v14
    v_lshlrev_b32 v15, 4, v15
    v_add_u32 v13, v9, v15
    v_and_b32 v9, 15, v1
    v_lshrrev_b32 v14, 2, v9
    v_lshlrev_b32 v15, 3, v7
    v_add_u32 v15, v15, v14
    v_lshlrev_b32 v15, 8, v15
    v_and_b32 v9, 3, v9
    v_lshlrev_b32 v9, 3, v9
    v_add_u32 v15, v15, v9
    v_lshrrev_b32 v9, 4, v1
    v_and_b32 v9, 1, v9
    v_lshlrev_b32 v9, 5, v9
    v_add_u32 v15, v15, v9
    v_add_u32 v15, 16384, v15
    v_lshlrev_b32 v9, 1, v4
    v_xor_b32 v7, v9, v14
    v_lshlrev_b32 v7, 6, v7
    v_add_u32 v7, v15, v7
    v_add_u32 v9, 1, v9
    v_xor_b32 v9, v9, v14
    v_lshlrev_b32 v9, 6, v9
    v_add_u32 v15, v15, v9
    s_add_u32 m0, s53, 0
    s_add_u32 s31, s28, 0
    buffer_load_dwordx4 v5, s[12:15], s31 offen lds
    s_add_u32 m0, s53, 4096
    s_add_u32 s31, s28, 32768
    buffer_load_dwordx4 v5, s[12:15], s31 offen lds
    s_add_u32 m0, s53, 8192
    s_add_u32 s31, s28, 65536
    buffer_load_dwordx4 v5, s[12:15], s31 offen lds
    s_add_u32 m0, s53, 12288
    s_add_u32 s31, s28, 98304
    buffer_load_dwordx4 v5, s[12:15], s31 offen lds
    s_add_u32 m0, s53, 16384
    s_add_u32 s31, s29, 0
    buffer_load_dwordx4 v8, s[16:19], s31 offen lds
    s_add_u32 m0, s53, 20480
    s_add_u32 s31, s29, 57344
    buffer_load_dwordx4 v8, s[16:19], s31 offen lds
    s_add_u32 m0, s53, 24576
    s_add_u32 s31, s29, 114688
    buffer_load_dwordx4 v8, s[16:19], s31 offen lds
    s_add_u32 m0, s53, 28672
    s_add_u32 s31, s29, 172032
    buffer_load_dwordx4 v8, s[16:19], s31 offen lds
    s_add_u32 s28, s28, 128
    s_add_u32 s29, s29, 229376
    v_mov_b32 v16, 0
    v_mov_b32 v17, 0
    v_mov_b32 v18, 0
    v_mov_b32 v19, 0
    v_mov_b32 v20, 0
    v_mov_b32 v21, 0
    v_mov_b32 v22, 0
    v_mov_b32 v23, 0
    v_mov_b32 v24, 0
    v_mov_b32 v25, 0
    v_mov_b32 v26, 0
    v_mov_b32 v27, 0
    v_mov_b32 v28, 0
    v_mov_b32 v29, 0
    v_mov_b32 v30, 0
    v_mov_b32 v31, 0
    v_mov_b32 v32, 0
    v_mov_b32 v33, 0
    v_mov_b32 v34, 0
    v_mov_b32 v35, 0
    v_mov_b32 v36, 0
    v_mov_b32 v37, 0
    v_mov_b32 v38, 0
    v_mov_b32 v39, 0
    v_mov_b32 v40, 0
    v_mov_b32 v41, 0
    v_mov_b32 v42, 0
    v_mov_b32 v43, 0
    v_mov_b32 v44, 0
    v_mov_b32 v45, 0
    v_mov_b32 v46, 0
    v_mov_b32 v47, 0
    v_mov_b32 v48, 0
    v_mov_b32 v49, 0
    v_mov_b32 v50, 0
    v_mov_b32 v51, 0
    v_mov_b32 v52, 0
    v_mov_b32 v53, 0
    v_mov_b32 v54, 0
    v_mov_b32 v55, 0
    v_mov_b32 v56, 0
    v_mov_b32 v57, 0
    v_mov_b32 v58, 0
    v_mov_b32 v59, 0
    v_mov_b32 v60, 0
    v_mov_b32 v61, 0
    v_mov_b32 v62, 0
    v_mov_b32 v63, 0
    v_mov_b32 v64, 0
    v_mov_b32 v65, 0
    v_mov_b32 v66, 0
    v_mov_b32 v67, 0
    v_mov_b32 v68, 0
    v_mov_b32 v69, 0
    v_mov_b32 v70, 0
    v_mov_b32 v71, 0
    v_mov_b32 v72, 0
    v_mov_b32 v73, 0
    v_mov_b32 v74, 0
    v_mov_b32 v75, 0
    v_mov_b32 v76, 0
    v_mov_b32 v77, 0
    v_mov_b32 v78, 0
    v_mov_b32 v79, 0
    s_mov_b32 s30, 4
    s_nop 3
.Lffn1_kernel_loop:
    s_waitcnt vmcnt(0)
    s_barrier
    ds_read_b128 v[80:83], v10 offset:0
    ds_read_b128 v[84:87], v10 offset:4096
    ds_read_b64_tr_b16 v[96:97], v7 offset:0
    ds_read_b64_tr_b16 v[98:99], v7 offset:1024
    ds_read_b64_tr_b16 v[100:101], v15 offset:0
    ds_read_b64_tr_b16 v[102:103], v15 offset:1024
    ds_read_b128 v[88:91], v11 offset:0
    ds_read_b128 v[92:95], v11 offset:4096
    ds_read_b64_tr_b16 v[104:105], v7 offset:4096
    ds_read_b64_tr_b16 v[106:107], v7 offset:5120
    ds_read_b64_tr_b16 v[108:109], v15 offset:4096
    ds_read_b64_tr_b16 v[110:111], v15 offset:5120
    s_waitcnt lgkmcnt(6)
    v_mfma_f32_32x32x16_bf16 v[16:31], v[96:99], v[80:83], v[16:31]
    s_add_u32 m0, s53, 32768
    s_add_u32 s31, s28, 0
    buffer_load_dwordx4 v5, s[12:15], s31 offen lds
    v_mfma_f32_32x32x16_bf16 v[32:47], v[100:103], v[80:83], v[32:47]
    s_add_u32 m0, s53, 36864
    s_add_u32 s31, s28, 32768
    buffer_load_dwordx4 v5, s[12:15], s31 offen lds
    v_mfma_f32_32x32x16_bf16 v[48:63], v[96:99], v[84:87], v[48:63]
    s_add_u32 m0, s53, 40960
    s_add_u32 s31, s28, 65536
    buffer_load_dwordx4 v5, s[12:15], s31 offen lds
    v_mfma_f32_32x32x16_bf16 v[64:79], v[100:103], v[84:87], v[64:79]
    s_add_u32 m0, s53, 45056
    s_add_u32 s31, s28, 98304
    buffer_load_dwordx4 v5, s[12:15], s31 offen lds
    ds_read_b128 v[80:83], v12 offset:0
    ds_read_b128 v[84:87], v12 offset:4096
    ds_read_b64_tr_b16 v[96:97], v7 offset:8192
    ds_read_b64_tr_b16 v[98:99], v7 offset:9216
    ds_read_b64_tr_b16 v[100:101], v15 offset:8192
    ds_read_b64_tr_b16 v[102:103], v15 offset:9216
    s_waitcnt lgkmcnt(6)
    v_mfma_f32_32x32x16_bf16 v[16:31], v[104:107], v[88:91], v[16:31]
    s_add_u32 m0, s53, 49152
    s_add_u32 s31, s29, 0
    buffer_load_dwordx4 v8, s[16:19], s31 offen lds
    v_mfma_f32_32x32x16_bf16 v[32:47], v[108:111], v[88:91], v[32:47]
    s_add_u32 m0, s53, 53248
    s_add_u32 s31, s29, 57344
    buffer_load_dwordx4 v8, s[16:19], s31 offen lds
    v_mfma_f32_32x32x16_bf16 v[48:63], v[104:107], v[92:95], v[48:63]
    s_add_u32 m0, s53, 57344
    s_add_u32 s31, s29, 114688
    buffer_load_dwordx4 v8, s[16:19], s31 offen lds
    v_mfma_f32_32x32x16_bf16 v[64:79], v[108:111], v[92:95], v[64:79]
    s_add_u32 m0, s53, 61440
    s_add_u32 s31, s29, 172032
    buffer_load_dwordx4 v8, s[16:19], s31 offen lds
    s_add_u32 s28, s28, 128
    s_add_u32 s29, s29, 229376
    ds_read_b128 v[88:91], v13 offset:0
    ds_read_b128 v[92:95], v13 offset:4096
    ds_read_b64_tr_b16 v[104:105], v7 offset:12288
    ds_read_b64_tr_b16 v[106:107], v7 offset:13312
    ds_read_b64_tr_b16 v[108:109], v15 offset:12288
    ds_read_b64_tr_b16 v[110:111], v15 offset:13312
    s_waitcnt lgkmcnt(6)
    v_mfma_f32_32x32x16_bf16 v[16:31], v[96:99], v[80:83], v[16:31]
    v_mfma_f32_32x32x16_bf16 v[32:47], v[100:103], v[80:83], v[32:47]
    v_mfma_f32_32x32x16_bf16 v[48:63], v[96:99], v[84:87], v[48:63]
    v_mfma_f32_32x32x16_bf16 v[64:79], v[100:103], v[84:87], v[64:79]
    s_waitcnt lgkmcnt(0)
    v_mfma_f32_32x32x16_bf16 v[16:31], v[104:107], v[88:91], v[16:31]
    v_mfma_f32_32x32x16_bf16 v[32:47], v[108:111], v[88:91], v[32:47]
    v_mfma_f32_32x32x16_bf16 v[48:63], v[104:107], v[92:95], v[48:63]
    v_mfma_f32_32x32x16_bf16 v[64:79], v[108:111], v[92:95], v[64:79]
    s_waitcnt vmcnt(0)
    s_barrier
    ds_read_b128 v[80:83], v10 offset:32768
    ds_read_b128 v[84:87], v10 offset:36864
    ds_read_b64_tr_b16 v[96:97], v7 offset:32768
    ds_read_b64_tr_b16 v[98:99], v7 offset:33792
    ds_read_b64_tr_b16 v[100:101], v15 offset:32768
    ds_read_b64_tr_b16 v[102:103], v15 offset:33792
    ds_read_b128 v[88:91], v11 offset:32768
    ds_read_b128 v[92:95], v11 offset:36864
    ds_read_b64_tr_b16 v[104:105], v7 offset:36864
    ds_read_b64_tr_b16 v[106:107], v7 offset:37888
    ds_read_b64_tr_b16 v[108:109], v15 offset:36864
    ds_read_b64_tr_b16 v[110:111], v15 offset:37888
    s_waitcnt lgkmcnt(6)
    v_mfma_f32_32x32x16_bf16 v[16:31], v[96:99], v[80:83], v[16:31]
    s_add_u32 m0, s53, 0
    s_add_u32 s31, s28, 0
    buffer_load_dwordx4 v5, s[12:15], s31 offen lds
    v_mfma_f32_32x32x16_bf16 v[32:47], v[100:103], v[80:83], v[32:47]
    s_add_u32 m0, s53, 4096
    s_add_u32 s31, s28, 32768
    buffer_load_dwordx4 v5, s[12:15], s31 offen lds
    v_mfma_f32_32x32x16_bf16 v[48:63], v[96:99], v[84:87], v[48:63]
    s_add_u32 m0, s53, 8192
    s_add_u32 s31, s28, 65536
    buffer_load_dwordx4 v5, s[12:15], s31 offen lds
    v_mfma_f32_32x32x16_bf16 v[64:79], v[100:103], v[84:87], v[64:79]
    s_add_u32 m0, s53, 12288
    s_add_u32 s31, s28, 98304
    buffer_load_dwordx4 v5, s[12:15], s31 offen lds
    ds_read_b128 v[80:83], v12 offset:32768
    ds_read_b128 v[84:87], v12 offset:36864
    ds_read_b64_tr_b16 v[96:97], v7 offset:40960
    ds_read_b64_tr_b16 v[98:99], v7 offset:41984
    ds_read_b64_tr_b16 v[100:101], v15 offset:40960
    ds_read_b64_tr_b16 v[102:103], v15 offset:41984
    s_waitcnt lgkmcnt(6)
    v_mfma_f32_32x32x16_bf16 v[16:31], v[104:107], v[88:91], v[16:31]
    s_add_u32 m0, s53, 16384
    s_add_u32 s31, s29, 0
    buffer_load_dwordx4 v8, s[16:19], s31 offen lds
    v_mfma_f32_32x32x16_bf16 v[32:47], v[108:111], v[88:91], v[32:47]
    s_add_u32 m0, s53, 20480
    s_add_u32 s31, s29, 57344
    buffer_load_dwordx4 v8, s[16:19], s31 offen lds
    v_mfma_f32_32x32x16_bf16 v[48:63], v[104:107], v[92:95], v[48:63]
    s_add_u32 m0, s53, 24576
    s_add_u32 s31, s29, 114688
    buffer_load_dwordx4 v8, s[16:19], s31 offen lds
    v_mfma_f32_32x32x16_bf16 v[64:79], v[108:111], v[92:95], v[64:79]
    s_add_u32 m0, s53, 28672
    s_add_u32 s31, s29, 172032
    buffer_load_dwordx4 v8, s[16:19], s31 offen lds
    s_add_u32 s28, s28, 128
    s_add_u32 s29, s29, 229376
    ds_read_b128 v[88:91], v13 offset:32768
    ds_read_b128 v[92:95], v13 offset:36864
    ds_read_b64_tr_b16 v[104:105], v7 offset:45056
    ds_read_b64_tr_b16 v[106:107], v7 offset:46080
    ds_read_b64_tr_b16 v[108:109], v15 offset:45056
    ds_read_b64_tr_b16 v[110:111], v15 offset:46080
    s_waitcnt lgkmcnt(6)
    v_mfma_f32_32x32x16_bf16 v[16:31], v[96:99], v[80:83], v[16:31]
    v_mfma_f32_32x32x16_bf16 v[32:47], v[100:103], v[80:83], v[32:47]
    v_mfma_f32_32x32x16_bf16 v[48:63], v[96:99], v[84:87], v[48:63]
    v_mfma_f32_32x32x16_bf16 v[64:79], v[100:103], v[84:87], v[64:79]
    s_waitcnt lgkmcnt(0)
    v_mfma_f32_32x32x16_bf16 v[16:31], v[104:107], v[88:91], v[16:31]
    v_mfma_f32_32x32x16_bf16 v[32:47], v[108:111], v[88:91], v[32:47]
    v_mfma_f32_32x32x16_bf16 v[48:63], v[104:107], v[92:95], v[48:63]
    v_mfma_f32_32x32x16_bf16 v[64:79], v[108:111], v[92:95], v[64:79]
    s_sub_u32 s30, s30, 1
    s_cmp_lg_u32 s30, 0
    s_nop 9
    s_cbranch_scc1 .Lffn1_kernel_loop
    s_waitcnt vmcnt(0)
    v_lshlrev_b32 v5, 6, v3
    v_add_u32 v5, v5, v6
    v_lshlrev_b32 v7, 6, v4
    v_lshrrev_b32 v8, 5, v1
    v_lshlrev_b32 v8, 2, v8
    v_add_u32 v7, v7, v8
    s_barrier
    v_mul_u32_u24 v9, 272, v5
    v_lshlrev_b32 v10, 1, v7
    v_add_u32 v9, v9, v10
    v_max_f32 v16, 0, v16
    v_max_f32 v17, 0, v17
    v_max_f32 v18, 0, v18
    v_max_f32 v19, 0, v19
    v_cvt_pk_bf16_f32 v16, v16, v17
    v_cvt_pk_bf16_f32 v17, v18, v19
    ds_write_b64 v9, v[16:17] offset:0
    v_max_f32 v20, 0, v20
    v_max_f32 v21, 0, v21
    v_max_f32 v22, 0, v22
    v_max_f32 v23, 0, v23
    v_cvt_pk_bf16_f32 v20, v20, v21
    v_cvt_pk_bf16_f32 v21, v22, v23
    ds_write_b64 v9, v[20:21] offset:16
    v_max_f32 v24, 0, v24
    v_max_f32 v25, 0, v25
    v_max_f32 v26, 0, v26
    v_max_f32 v27, 0, v27
    v_cvt_pk_bf16_f32 v24, v24, v25
    v_cvt_pk_bf16_f32 v25, v26, v27
    ds_write_b64 v9, v[24:25] offset:32
    v_max_f32 v28, 0, v28
    v_max_f32 v29, 0, v29
    v_max_f32 v30, 0, v30
    v_max_f32 v31, 0, v31
    v_cvt_pk_bf16_f32 v28, v28, v29
    v_cvt_pk_bf16_f32 v29, v30, v31
    ds_write_b64 v9, v[28:29] offset:48
    v_max_f32 v32, 0, v32
    v_max_f32 v33, 0, v33
    v_max_f32 v34, 0, v34
    v_max_f32 v35, 0, v35
    v_cvt_pk_bf16_f32 v32, v32, v33
    v_cvt_pk_bf16_f32 v33, v34, v35
    ds_write_b64 v9, v[32:33] offset:64
    v_max_f32 v36, 0, v36
    v_max_f32 v37, 0, v37
    v_max_f32 v38, 0, v38
    v_max_f32 v39, 0, v39
    v_cvt_pk_bf16_f32 v36, v36, v37
    v_cvt_pk_bf16_f32 v37, v38, v39
    ds_write_b64 v9, v[36:37] offset:80
    v_max_f32 v40, 0, v40
    v_max_f32 v41, 0, v41
    v_max_f32 v42, 0, v42
    v_max_f32 v43, 0, v43
    v_cvt_pk_bf16_f32 v40, v40, v41
    v_cvt_pk_bf16_f32 v41, v42, v43
    ds_write_b64 v9, v[40:41] offset:96
    v_max_f32 v44, 0, v44
    v_max_f32 v45, 0, v45
    v_max_f32 v46, 0, v46
    v_max_f32 v47, 0, v47
    v_cvt_pk_bf16_f32 v44, v44, v45
    v_cvt_pk_bf16_f32 v45, v46, v47
    ds_write_b64 v9, v[44:45] offset:112
    v_max_f32 v48, 0, v48
    v_max_f32 v49, 0, v49
    v_max_f32 v50, 0, v50
    v_max_f32 v51, 0, v51
    v_cvt_pk_bf16_f32 v48, v48, v49
    v_cvt_pk_bf16_f32 v49, v50, v51
    ds_write_b64 v9, v[48:49] offset:8704
    v_max_f32 v52, 0, v52
    v_max_f32 v53, 0, v53
    v_max_f32 v54, 0, v54
    v_max_f32 v55, 0, v55
    v_cvt_pk_bf16_f32 v52, v52, v53
    v_cvt_pk_bf16_f32 v53, v54, v55
    ds_write_b64 v9, v[52:53] offset:8720
    v_max_f32 v56, 0, v56
    v_max_f32 v57, 0, v57
    v_max_f32 v58, 0, v58
    v_max_f32 v59, 0, v59
    v_cvt_pk_bf16_f32 v56, v56, v57
    v_cvt_pk_bf16_f32 v57, v58, v59
    ds_write_b64 v9, v[56:57] offset:8736
    v_max_f32 v60, 0, v60
    v_max_f32 v61, 0, v61
    v_max_f32 v62, 0, v62
    v_max_f32 v63, 0, v63
    v_cvt_pk_bf16_f32 v60, v60, v61
    v_cvt_pk_bf16_f32 v61, v62, v63
    ds_write_b64 v9, v[60:61] offset:8752
    v_max_f32 v64, 0, v64
    v_max_f32 v65, 0, v65
    v_max_f32 v66, 0, v66
    v_max_f32 v67, 0, v67
    v_cvt_pk_bf16_f32 v64, v64, v65
    v_cvt_pk_bf16_f32 v65, v66, v67
    ds_write_b64 v9, v[64:65] offset:8768
    v_max_f32 v68, 0, v68
    v_max_f32 v69, 0, v69
    v_max_f32 v70, 0, v70
    v_max_f32 v71, 0, v71
    v_cvt_pk_bf16_f32 v68, v68, v69
    v_cvt_pk_bf16_f32 v69, v70, v71
    ds_write_b64 v9, v[68:69] offset:8784
    v_max_f32 v72, 0, v72
    v_max_f32 v73, 0, v73
    v_max_f32 v74, 0, v74
    v_max_f32 v75, 0, v75
    v_cvt_pk_bf16_f32 v72, v72, v73
    v_cvt_pk_bf16_f32 v73, v74, v75
    ds_write_b64 v9, v[72:73] offset:8800
    v_max_f32 v76, 0, v76
    v_max_f32 v77, 0, v77
    v_max_f32 v78, 0, v78
    v_max_f32 v79, 0, v79
    v_cvt_pk_bf16_f32 v76, v76, v77
    v_cvt_pk_bf16_f32 v77, v78, v79
    ds_write_b64 v9, v[76:77] offset:8816
    v_lshrrev_b32 v3, 4, v0
    v_and_b32 v4, 15, v0
    v_lshlrev_b32 v4, 4, v4
    v_mul_u32_u24 v9, 272, v3
    v_add_u32 v9, v9, v4
    v_mul_u32_u24 v10, 3584, v3
    v_add_u32 v10, v10, v4
    v_add_u32 v10, s26, v10
    s_waitcnt lgkmcnt(0)
    s_barrier
    ds_read_b128 v[16:19], v9 offset:0
    ds_read_b128 v[20:23], v9 offset:4352
    ds_read_b128 v[24:27], v9 offset:8704
    ds_read_b128 v[28:31], v9 offset:13056
    ds_read_b128 v[32:35], v9 offset:17408
    ds_read_b128 v[36:39], v9 offset:21760
    ds_read_b128 v[40:43], v9 offset:26112
    ds_read_b128 v[44:47], v9 offset:30464
    s_waitcnt lgkmcnt(7)
    s_mov_b32 s31, 0
    buffer_store_dwordx4 v[16:19], v10, s[20:23], s31 offen
    s_waitcnt lgkmcnt(6)
    s_mov_b32 s31, 57344
    buffer_store_dwordx4 v[20:23], v10, s[20:23], s31 offen
    s_waitcnt lgkmcnt(5)
    s_mov_b32 s31, 114688
    buffer_store_dwordx4 v[24:27], v10, s[20:23], s31 offen
    s_waitcnt lgkmcnt(4)
    s_mov_b32 s31, 172032
    buffer_store_dwordx4 v[28:31], v10, s[20:23], s31 offen
    s_waitcnt lgkmcnt(3)
    s_mov_b32 s31, 229376
    buffer_store_dwordx4 v[32:35], v10, s[20:23], s31 offen
    s_waitcnt lgkmcnt(2)
    s_mov_b32 s31, 286720
    buffer_store_dwordx4 v[36:39], v10, s[20:23], s31 offen
    s_waitcnt lgkmcnt(1)
    s_mov_b32 s31, 344064
    buffer_store_dwordx4 v[40:43], v10, s[20:23], s31 offen
    s_waitcnt lgkmcnt(0)
    s_mov_b32 s31, 401408
    buffer_store_dwordx4 v[44:47], v10, s[20:23], s31 offen
    s_nop 1
.Lffn1_kernel_end:
    s_endpgm
.globl ffn2_kernel
.p2align 8
.type ffn2_kernel,@function
ffn2_kernel:
    s_cmp_ge_u32 s2, 256
    s_cbranch_scc1 .Lffn2_kernel_end
    s_load_dwordx2 s[40:41], s[0:1], 64
    s_load_dwordx2 s[42:43], s[0:1], 0
    s_load_dwordx2 s[44:45], s[0:1], 88
    s_load_dwordx2 s[8:9], s[0:1], 104
    s_waitcnt lgkmcnt(0)
    s_and_b32 s46, s2, 31
    s_lshr_b32 s47, s2, 5
    s_add_u32 s12, s8, 0x4800000
    s_addc_u32 s13, s9, 0x0
    s_and_b32 s13, s13, 0xffff
    s_mov_b32 s14, 0x700000
    s_mov_b32 s15, 0x20000
    s_mov_b32 s16, s40
    s_and_b32 s17, s41, 0xffff
    s_mov_b32 s18, 0x1c0000
    s_mov_b32 s19, 0x20000
    s_mov_b32 s20, s44
    s_and_b32 s21, s45, 0xffff
    s_mov_b32 s22, 0x200000
    s_mov_b32 s23, 0x20000
    s_add_u32 s32, s8, 0x4400000
    s_addc_u32 s33, s9, 0x0
    s_and_b32 s33, s33, 0xffff
    s_mov_b32 s34, 0x200000
    s_mov_b32 s35, 0x20000
    s_mov_b32 s36, s8
    s_and_b32 s37, s9, 0xffff
    s_mov_b32 s38, 0x3000
    s_mov_b32 s39, 0x20000
    s_mul_i32 s24, s46, 229376
    s_lshl_b32 s25, s47, 7
    s_mul_i32 s26, s46, 65536
    s_add_u32 s26, s26, s25
    s_lshl_b32 s27, s47, 6
    v_and_b32 v1, 63, v0
    v_lshrrev_b32 v2, 6, v0
    v_lshrrev_b32 v3, 3, v0
    v_and_b32 v4, 7, v0
    v_mul_u32_u24 v5, 3584, v3
    v_lshlrev_b32 v6, 4, v4
    v_add_u32 v5, v5, v6
    v_add_u32 v5, s24, v5
    v_mul_u32_u24 v7, 144, v3
    v_add_u32 v7, v7, v6
    v_lshrrev_b32 v3, 3, v0
    v_and_b32 v4, 7, v0
    v_mul_u32_u24 v8, 1024, v3
    v_lshlrev_b32 v6, 4, v4
    v_add_u32 v8, v8, v6
    v_add_u32 v8, s25, v8
    v_mul_u32_u24 v9, 192, v3
    v_add_u32 v9, v9, v6
    v_add_u32 v9, 9216, v9
    v_lshrrev_b32 v3, 1, v2
    v_and_b32 v4, 1, v2
    v_and_b32 v6, 31, v1
    v_mul_u32_u24 v10, 32, v3
    v_add_u32 v10, v10, v6
    v_mul_u32_u24 v10, 144, v10
    v_lshrrev_b32 v11, 5, v1
    v_lshlrev_b32 v12, 4, v11
    v_add_u32 v10, v10, v12
    v_and_b32 v12, 15, v1
    v_lshrrev_b32 v13, 2, v12
    v_lshlrev_b32 v14, 3, v11
    v_add_u32 v13, v13, v14
    v_mul_u32_u24 v13, 192, v13
    v_lshrrev_b32 v14, 4, v1
    v_and_b32 v14, 1, v14
    v_lshlrev_b32 v14, 4, v14
    v_and_b32 v15, 3, v12
    v_lshlrev_b32 v15, 2, v15
    v_add_u32 v14, v14, v15
    v_mul_u32_u24 v15, 32, v4
    v_add_u32 v14, v14, v15
    v_lshlrev_b32 v14, 1, v14
    v_add_u32 v13, v13, v14
    v_add_u32 v13, 9216, v13
    v_add_u32 v11, 21504, v10
    v_add_u32 v14, 21504, v13
    v_add_u32 v12, 21504, v7
    v_add_u32 v15, 21504, v9
    s_mov_b32 s28, 0
    s_mov_b32 s29, 0
    buffer_load_dwordx4 v[48:51], v5, s[12:15], s28 offen offset:0
    s_add_u32 s31, s28, 114688
    buffer_load_dwordx4 v[52:55], v5, s[12:15], s31 offen
    buffer_load_dwordx4 v[56:59], v8, s[16:19], s29 offen offset:0
    s_add_u32 s31, s29, 32768
    buffer_load_dwordx4 v[60:63], v8, s[16:19], s31 offen
    s_add_u32 s28, s28, 128
    s_add_u32 s29, s29, 65536
    buffer_load_dwordx4 v[64:67], v5, s[12:15], s28 offen offset:0
    s_add_u32 s31, s28, 114688
    buffer_load_dwordx4 v[68:71], v5, s[12:15], s31 offen
    buffer_load_dwordx4 v[72:75], v8, s[16:19], s29 offen offset:0
    s_add_u32 s31, s29, 32768
    buffer_load_dwordx4 v[76:79], v8, s[16:19], s31 offen
    s_add_u32 s28, s28, 128
    s_add_u32 s29, s29, 65536
    v_mov_b32 v16, 0
    v_mov_b32 v17, 0
    v_mov_b32 v18, 0
    v_mov_b32 v19, 0
    v_mov_b32 v20, 0
    v_mov_b32 v21, 0
    v_mov_b32 v22, 0
    v_mov_b32 v23, 0
    v_mov_b32 v24, 0
    v_mov_b32 v25, 0
    v_mov_b32 v26, 0
    v_mov_b32 v27, 0
    v_mov_b32 v28, 0
    v_mov_b32 v29, 0
    v_mov_b32 v30, 0
    v_mov_b32 v31, 0
    s_waitcnt vmcnt(4)
    ds_write_b128 v7, v[48:51] offset:0
    ds_write_b128 v7, v[52:55] offset:4608
    ds_write_b128 v9, v[56:59] offset:0
    ds_write_b128 v9, v[60:63] offset:6144
    buffer_load_dwordx4 v[48:51], v5, s[12:15], s28 offen offset:0
    s_add_u32 s31, s28, 114688
    buffer_load_dwordx4 v[52:55], v5, s[12:15], s31 offen
    buffer_load_dwordx4 v[56:59], v8, s[16:19], s29 offen offset:0
    s_add_u32 s31, s29, 32768
    buffer_load_dwordx4 v[60:63], v8, s[16:19], s31 offen
    s_add_u32 s28, s28, 128
    s_add_u32 s29, s29, 65536
    s_waitcnt lgkmcnt(0)
    s_barrier
    s_mov_b32 s30, 14
.Lffn2_kernel_loop:
    ds_read_b128 v[32:35], v10 offset:0
    ds_read_b64_tr_b16 v[40:41], v13 offset:0
    ds_read_b64_tr_b16 v[42:43], v13 offset:768
    ds_read_b128 v[36:39], v10 offset:32
    ds_read_b64_tr_b16 v[44:45], v13 offset:3072
    ds_read_b64_tr_b16 v[46:47], v13 offset:3840
    s_waitcnt lgkmcnt(3)
    v_mfma_f32_32x32x16_bf16 v[16:31], v[40:43], v[32:35], v[16:31]
    ds_read_b128 v[32:35], v10 offset:64
    ds_read_b64_tr_b16 v[40:41], v13 offset:6144
    ds_read_b64_tr_b16 v[42:43], v13 offset:6912
    s_waitcnt lgkmcnt(3)
    v_mfma_f32_32x32x16_bf16 v[16:31], v[44:47], v[36:39], v[16:31]
    ds_read_b128 v[36:39], v10 offset:96
    ds_read_b64_tr_b16 v[44:45], v13 offset:9216
    ds_read_b64_tr_b16 v[46:47], v13 offset:9984
    s_waitcnt lgkmcnt(3)
    v_mfma_f32_32x32x16_bf16 v[16:31], v[40:43], v[32:35], v[16:31]
    s_waitcnt lgkmcnt(0)
    v_mfma_f32_32x32x16_bf16 v[16:31], v[44:47], v[36:39], v[16:31]
    s_waitcnt vmcnt(4)
    ds_write_b128 v12, v[64:67] offset:0
    ds_write_b128 v12, v[68:71] offset:4608
    ds_write_b128 v15, v[72:75] offset:0
    ds_write_b128 v15, v[76:79] offset:6144
    buffer_load_dwordx4 v[64:67], v5, s[12:15], s28 offen offset:0
    s_add_u32 s31, s28, 114688
    buffer_load_dwordx4 v[68:71], v5, s[12:15], s31 offen
    buffer_load_dwordx4 v[72:75], v8, s[16:19], s29 offen offset:0
    s_add_u32 s31, s29, 32768
    buffer_load_dwordx4 v[76:79], v8, s[16:19], s31 offen
    s_add_u32 s28, s28, 128
    s_add_u32 s29, s29, 65536
    s_waitcnt lgkmcnt(0)
    s_barrier
    ds_read_b128 v[32:35], v11 offset:0
    ds_read_b64_tr_b16 v[40:41], v14 offset:0
    ds_read_b64_tr_b16 v[42:43], v14 offset:768
    ds_read_b128 v[36:39], v11 offset:32
    ds_read_b64_tr_b16 v[44:45], v14 offset:3072
    ds_read_b64_tr_b16 v[46:47], v14 offset:3840
    s_waitcnt lgkmcnt(3)
    v_mfma_f32_32x32x16_bf16 v[16:31], v[40:43], v[32:35], v[16:31]
    ds_read_b128 v[32:35], v11 offset:64
    ds_read_b64_tr_b16 v[40:41], v14 offset:6144
    ds_read_b64_tr_b16 v[42:43], v14 offset:6912
    s_waitcnt lgkmcnt(3)
    v_mfma_f32_32x32x16_bf16 v[16:31], v[44:47], v[36:39], v[16:31]
    ds_read_b128 v[36:39], v11 offset:96
    ds_read_b64_tr_b16 v[44:45], v14 offset:9216
    ds_read_b64_tr_b16 v[46:47], v14 offset:9984
    s_waitcnt lgkmcnt(3)
    v_mfma_f32_32x32x16_bf16 v[16:31], v[40:43], v[32:35], v[16:31]
    s_waitcnt lgkmcnt(0)
    v_mfma_f32_32x32x16_bf16 v[16:31], v[44:47], v[36:39], v[16:31]
    s_waitcnt vmcnt(4)
    ds_write_b128 v7, v[48:51] offset:0
    ds_write_b128 v7, v[52:55] offset:4608
    ds_write_b128 v9, v[56:59] offset:0
    ds_write_b128 v9, v[60:63] offset:6144
    buffer_load_dwordx4 v[48:51], v5, s[12:15], s28 offen offset:0
    s_add_u32 s31, s28, 114688
    buffer_load_dwordx4 v[52:55], v5, s[12:15], s31 offen
    buffer_load_dwordx4 v[56:59], v8, s[16:19], s29 offen offset:0
    s_add_u32 s31, s29, 32768
    buffer_load_dwordx4 v[60:63], v8, s[16:19], s31 offen
    s_add_u32 s28, s28, 128
    s_add_u32 s29, s29, 65536
    s_waitcnt lgkmcnt(0)
    s_barrier
    s_sub_u32 s30, s30, 1
    s_cmp_lg_u32 s30, 0
    s_cbranch_scc1 .Lffn2_kernel_loop
    s_waitcnt vmcnt(0)
    v_mul_u32_u24 v5, 32, v3
    v_add_u32 v5, v5, v6
    v_mul_u32_u24 v7, 32, v4
    v_lshrrev_b32 v8, 5, v1
    v_lshlrev_b32 v8, 2, v8
    v_add_u32 v7, v7, v8
    v_mul_u32_u24 v9, 1024, v5
    v_lshlrev_b32 v10, 1, v7
    v_add_u32 v9, v9, v10
    v_add_u32 v9, s26, v9
    v_add_u32 v11, s27, v7
    v_lshlrev_b32 v11, 2, v11
    v_add_u32 v11, 10240, v11
    s_mov_b32 s31, 0
    buffer_load_dwordx2 v[80:81], v9, s[32:35], s31 offen
    buffer_load_dwordx4 v[84:87], v11, s[36:39], 0 offen offset:0
    v_cvt_pk_bf16_f32 v16, v16, v16
    v_lshlrev_b32 v16, 16, v16
    v_cvt_pk_bf16_f32 v17, v17, v17
    v_lshlrev_b32 v17, 16, v17
    v_cvt_pk_bf16_f32 v18, v18, v18
    v_lshlrev_b32 v18, 16, v18
    v_cvt_pk_bf16_f32 v19, v19, v19
    v_lshlrev_b32 v19, 16, v19
    s_waitcnt vmcnt(0)
    v_lshlrev_b32 v88, 16, v80
    v_and_b32 v89, 0xffff0000, v80
    v_lshlrev_b32 v90, 16, v81
    v_and_b32 v91, 0xffff0000, v81
    v_mul_f32 v16, v16, v84
    v_cvt_pk_bf16_f32 v16, v16, v16
    v_lshlrev_b32 v16, 16, v16
    v_add_f32 v16, v16, v88
    v_mul_f32 v17, v17, v85
    v_cvt_pk_bf16_f32 v17, v17, v17
    v_lshlrev_b32 v17, 16, v17
    v_add_f32 v17, v17, v89
    v_mul_f32 v18, v18, v86
    v_cvt_pk_bf16_f32 v18, v18, v18
    v_lshlrev_b32 v18, 16, v18
    v_add_f32 v18, v18, v90
    v_mul_f32 v19, v19, v87
    v_cvt_pk_bf16_f32 v19, v19, v19
    v_lshlrev_b32 v19, 16, v19
    v_add_f32 v19, v19, v91
    v_cvt_pk_bf16_f32 v16, v16, v17
    v_cvt_pk_bf16_f32 v17, v18, v19
    buffer_store_dwordx2 v[16:17], v9, s[20:23], s31 offen
    s_mov_b32 s31, 16
    buffer_load_dwordx2 v[80:81], v9, s[32:35], s31 offen
    buffer_load_dwordx4 v[84:87], v11, s[36:39], 0 offen offset:32
    v_cvt_pk_bf16_f32 v20, v20, v20
    v_lshlrev_b32 v20, 16, v20
    v_cvt_pk_bf16_f32 v21, v21, v21
    v_lshlrev_b32 v21, 16, v21
    v_cvt_pk_bf16_f32 v22, v22, v22
    v_lshlrev_b32 v22, 16, v22
    v_cvt_pk_bf16_f32 v23, v23, v23
    v_lshlrev_b32 v23, 16, v23
    s_waitcnt vmcnt(0)
    v_lshlrev_b32 v88, 16, v80
    v_and_b32 v89, 0xffff0000, v80
    v_lshlrev_b32 v90, 16, v81
    v_and_b32 v91, 0xffff0000, v81
    v_mul_f32 v20, v20, v84
    v_cvt_pk_bf16_f32 v20, v20, v20
    v_lshlrev_b32 v20, 16, v20
    v_add_f32 v20, v20, v88
    v_mul_f32 v21, v21, v85
    v_cvt_pk_bf16_f32 v21, v21, v21
    v_lshlrev_b32 v21, 16, v21
    v_add_f32 v21, v21, v89
    v_mul_f32 v22, v22, v86
    v_cvt_pk_bf16_f32 v22, v22, v22
    v_lshlrev_b32 v22, 16, v22
    v_add_f32 v22, v22, v90
    v_mul_f32 v23, v23, v87
    v_cvt_pk_bf16_f32 v23, v23, v23
    v_lshlrev_b32 v23, 16, v23
    v_add_f32 v23, v23, v91
    v_cvt_pk_bf16_f32 v20, v20, v21
    v_cvt_pk_bf16_f32 v21, v22, v23
    buffer_store_dwordx2 v[20:21], v9, s[20:23], s31 offen
    s_mov_b32 s31, 32
    buffer_load_dwordx2 v[80:81], v9, s[32:35], s31 offen
    buffer_load_dwordx4 v[84:87], v11, s[36:39], 0 offen offset:64
    v_cvt_pk_bf16_f32 v24, v24, v24
    v_lshlrev_b32 v24, 16, v24
    v_cvt_pk_bf16_f32 v25, v25, v25
    v_lshlrev_b32 v25, 16, v25
    v_cvt_pk_bf16_f32 v26, v26, v26
    v_lshlrev_b32 v26, 16, v26
    v_cvt_pk_bf16_f32 v27, v27, v27
    v_lshlrev_b32 v27, 16, v27
    s_waitcnt vmcnt(0)
    v_lshlrev_b32 v88, 16, v80
    v_and_b32 v89, 0xffff0000, v80
    v_lshlrev_b32 v90, 16, v81
    v_and_b32 v91, 0xffff0000, v81
    v_mul_f32 v24, v24, v84
    v_cvt_pk_bf16_f32 v24, v24, v24
    v_lshlrev_b32 v24, 16, v24
    v_add_f32 v24, v24, v88
    v_mul_f32 v25, v25, v85
    v_cvt_pk_bf16_f32 v25, v25, v25
    v_lshlrev_b32 v25, 16, v25
    v_add_f32 v25, v25, v89
    v_mul_f32 v26, v26, v86
    v_cvt_pk_bf16_f32 v26, v26, v26
    v_lshlrev_b32 v26, 16, v26
    v_add_f32 v26, v26, v90
    v_mul_f32 v27, v27, v87
    v_cvt_pk_bf16_f32 v27, v27, v27
    v_lshlrev_b32 v27, 16, v27
    v_add_f32 v27, v27, v91
    v_cvt_pk_bf16_f32 v24, v24, v25
    v_cvt_pk_bf16_f32 v25, v26, v27
    buffer_store_dwordx2 v[24:25], v9, s[20:23], s31 offen
    s_mov_b32 s31, 48
    buffer_load_dwordx2 v[80:81], v9, s[32:35], s31 offen
    buffer_load_dwordx4 v[84:87], v11, s[36:39], 0 offen offset:96
    v_cvt_pk_bf16_f32 v28, v28, v28
    v_lshlrev_b32 v28, 16, v28
    v_cvt_pk_bf16_f32 v29, v29, v29
    v_lshlrev_b32 v29, 16, v29
    v_cvt_pk_bf16_f32 v30, v30, v30
    v_lshlrev_b32 v30, 16, v30
    v_cvt_pk_bf16_f32 v31, v31, v31
    v_lshlrev_b32 v31, 16, v31
    s_waitcnt vmcnt(0)
    v_lshlrev_b32 v88, 16, v80
    v_and_b32 v89, 0xffff0000, v80
    v_lshlrev_b32 v90, 16, v81
    v_and_b32 v91, 0xffff0000, v81
    v_mul_f32 v28, v28, v84
    v_cvt_pk_bf16_f32 v28, v28, v28
    v_lshlrev_b32 v28, 16, v28
    v_add_f32 v28, v28, v88
    v_mul_f32 v29, v29, v85
    v_cvt_pk_bf16_f32 v29, v29, v29
    v_lshlrev_b32 v29, 16, v29
    v_add_f32 v29, v29, v89
    v_mul_f32 v30, v30, v86
    v_cvt_pk_bf16_f32 v30, v30, v30
    v_lshlrev_b32 v30, 16, v30
    v_add_f32 v30, v30, v90
    v_mul_f32 v31, v31, v87
    v_cvt_pk_bf16_f32 v31, v31, v31
    v_lshlrev_b32 v31, 16, v31
    v_add_f32 v31, v31, v91
    v_cvt_pk_bf16_f32 v28, v28, v29
    v_cvt_pk_bf16_f32 v29, v30, v31
    buffer_store_dwordx2 v[28:29], v9, s[20:23], s31 offen
    s_nop 3
.Lffn2_kernel_end:
    s_endpgm
.section .rodata,"a"
.p2align 6
.amdhsa_kernel mod_kernel
  .amdhsa_next_free_vgpr 96
  .amdhsa_next_free_sgpr 32
  .amdhsa_accum_offset 96
  .amdhsa_group_segment_fixed_size 0
  .amdhsa_kernarg_size 112
  .amdhsa_user_sgpr_count 2
  .amdhsa_user_sgpr_kernarg_segment_ptr 1
  .amdhsa_system_sgpr_workgroup_id_x 1
.end_amdhsa_kernel
.p2align 6
.amdhsa_kernel ln1_kernel
  .amdhsa_next_free_vgpr 96
  .amdhsa_next_free_sgpr 40
  .amdhsa_accum_offset 96
  .amdhsa_group_segment_fixed_size 0
  .amdhsa_kernarg_size 112
  .amdhsa_user_sgpr_count 2
  .amdhsa_user_sgpr_kernarg_segment_ptr 1
  .amdhsa_system_sgpr_workgroup_id_x 1
.end_amdhsa_kernel
.p2align 6
.amdhsa_kernel qkv_kernel
  .amdhsa_next_free_vgpr 128
  .amdhsa_next_free_sgpr 96
  .amdhsa_accum_offset 128
  .amdhsa_group_segment_fixed_size 0
  .amdhsa_kernarg_size 112
  .amdhsa_user_sgpr_count 2
  .amdhsa_user_sgpr_kernarg_segment_ptr 1
  .amdhsa_system_sgpr_workgroup_id_x 1
.end_amdhsa_kernel
.p2align 6
.amdhsa_kernel attn_kernel
  .amdhsa_next_free_vgpr 220
  .amdhsa_next_free_sgpr 96
  .amdhsa_accum_offset 220
  .amdhsa_group_segment_fixed_size 0
  .amdhsa_kernarg_size 112
  .amdhsa_user_sgpr_count 2
  .amdhsa_user_sgpr_kernarg_segment_ptr 1
  .amdhsa_system_sgpr_workgroup_id_x 1
.end_amdhsa_kernel
.p2align 6
.amdhsa_kernel oproj_kernel
  .amdhsa_next_free_vgpr 128
  .amdhsa_next_free_sgpr 56
  .amdhsa_accum_offset 128
  .amdhsa_group_segment_fixed_size 0
  .amdhsa_kernarg_size 112
  .amdhsa_user_sgpr_count 2
  .amdhsa_user_sgpr_kernarg_segment_ptr 1
  .amdhsa_system_sgpr_workgroup_id_x 1
.end_amdhsa_kernel
.p2align 6
.amdhsa_kernel ln2_kernel
  .amdhsa_next_free_vgpr 96
  .amdhsa_next_free_sgpr 40
  .amdhsa_accum_offset 96
  .amdhsa_group_segment_fixed_size 0
  .amdhsa_kernarg_size 112
  .amdhsa_user_sgpr_count 2
  .amdhsa_user_sgpr_kernarg_segment_ptr 1
  .amdhsa_system_sgpr_workgroup_id_x 1
.end_amdhsa_kernel
.p2align 6
.amdhsa_kernel ffn1_kernel
  .amdhsa_next_free_vgpr 128
  .amdhsa_next_free_sgpr 56
  .amdhsa_accum_offset 128
  .amdhsa_group_segment_fixed_size 0
  .amdhsa_kernarg_size 112
  .amdhsa_user_sgpr_count 2
  .amdhsa_user_sgpr_kernarg_segment_ptr 1
  .amdhsa_system_sgpr_workgroup_id_x 1
.end_amdhsa_kernel
.p2align 6
.amdhsa_kernel ffn2_kernel
  .amdhsa_next_free_vgpr 96
  .amdhsa_next_free_sgpr 56
  .amdhsa_accum_offset 96
  .amdhsa_group_segment_fixed_size 0
  .amdhsa_kernarg_size 112
  .amdhsa_user_sgpr_count 2
  .amdhsa_user_sgpr_kernarg_segment_ptr 1
  .amdhsa_system_sgpr_workgroup_id_x 1
.end_amdhsa_kernel
```
